```python
import torch

def _softmax(x, axis=-1):
    return torch.softmax(x, dim=axis)
def _gelu(x):
    return torch.nn.functional.gelu(x, approximate="tanh")
def _silu(x):
    return torch.nn.functional.silu(x)
def _sigmoid(x):
    return torch.sigmoid(x)
def _layernorm(x, axis=-1, eps=1e-5):
    m = x.mean(dim=axis, keepdim=True)
    v = x.var(dim=axis, keepdim=True, unbiased=False)
    return (x - m) / torch.sqrt(v + eps)
def _scatter_add(tgt, idx, src, axis=0):
    return tgt.clone().index_add_(axis, idx, src)
def _segment_sum(src, seg, n):
    out = torch.zeros((n,) + src.shape[1:], dtype=src.dtype)
    return out.index_add_(0, seg, src)
def _pad(x, pw):
    flat = tuple(v for pair in reversed(pw) for v in pair)
    return torch.nn.functional.pad(x, flat)

kernel_name = 'gated_mix__linear_attn_block__dense_activation_squared_relu__prompt'

def setup_inputs():

    _w = (lambda a: (lambda t: t.to(torch.bfloat16) if t.is_floating_point() else t)(torch.as_tensor(a)))
    def _A_setup():
        B, S, D = 1, 2048, 640
        return {
            "x": _w((lambda *s: torch.randn(*s, dtype=torch.bfloat16) * 0.05)(B, S, D)),
            "wqkv": _w((lambda *s: torch.randn(*s, dtype=torch.bfloat16) * 0.8)(D, 3 * D)),
            "wo": _w((lambda *s: torch.randn(*s, dtype=torch.bfloat16) * 0.2)(D, D)),
        }
    _A_in = _A_setup()

    def _B_setup():
        B, S, D, F = 1, 2048, 640, 1536
        return {
            "x": _w((lambda *s: torch.randn(*s, dtype=torch.bfloat16) * 0.05)(B, S, D)),
            "w1": _w((lambda *s: torch.randn(*s, dtype=torch.bfloat16) * 0.1)(D, F)),
            "b1": _w((lambda *s: torch.randn(*s, dtype=torch.bfloat16) * 0.05)(F)),
            "w2": _w((lambda *s: torch.randn(*s, dtype=torch.bfloat16) * 0.05)(F, D)),
            "b2": _w((lambda *s: torch.randn(*s, dtype=torch.bfloat16) * 0.05)(D)),
        }
    _B_in = _B_setup()

    return {
        "A_x": _A_in["x"],
        "A_wqkv": _A_in["wqkv"],
        "A_wo": _A_in["wo"],
        "B_x": _B_in["x"],
        "B_w1": _B_in["w1"],
        "B_b1": _B_in["b1"],
        "B_w2": _B_in["w2"],
        "B_b2": _B_in["b2"],
        "gate_w": _w((lambda *s: torch.randn(*s, dtype=torch.bfloat16) * 0.05)(640) * 16.0),
    }

def reference(A_x, A_wqkv, A_wo, B_x, B_w1, B_b1, B_w2, B_b2, gate_w):
    def _A_ref(x, wqkv, wo):
        B, S, D = x.shape
        H = 32; Dh = D // H
        qkv = (lambda x, *d: x.permute(*d))((x @ wqkv).reshape(B, S, 3, H, Dh), 2, 0, 3, 1, 4)
        q, k, v = qkv[0], qkv[1], qkv[2]
        phi = lambda t: torch.where(t > 0, t + 1, torch.exp(t)) + 1e-6
        pq, pk = phi(q), phi(k)
        kv = torch.einsum("bhsd,bhse->bhde", pk, v)
        z = torch.einsum("bhsd->bhd", pk)
        num = torch.einsum("bhqd,bhde->bhqe", pq, kv)
        den = torch.einsum("bhqd,bhd->bhq", pq, z)[..., None] + 1e-6
        o = num / den
        return (lambda x, *d: x.permute(*d))(o, 0, 2, 1, 3).reshape(B, S, D) @ wo

    def _B_ref(x, w1, b1, w2, b2):
        h = torch.einsum("bsd,df->bsf", x, w1) + b1
        zero = torch.zeros_like(h)
        r = torch.where(h > zero, h, zero)
        h = r * r
        out = torch.einsum("bsf,fd->bsd", h, w2) + b2
        return out

    x = A_x
    g = _sigmoid((x * gate_w).sum(-1, keepdims=True))
    a = _A_ref(x, A_wqkv, A_wo)
    b = _B_ref(x, B_w1, B_b1, B_w2, B_b2)
    return g * a + (1 - g) * b
```

```asm
; @launch kernel=s1_kernel grid=(256,1,1) block=(448,1,1) lds=151552
; @launch kernel=s2_kernel grid=(256,1,1) block=(512,1,1) lds=81920
.amdgcn_target "amdgcn-amd-amdhsa--gfx950"
.text
.globl s1_kernel
.p2align 8
.type s1_kernel,@function
s1_kernel:
  s_cmp_ge_u32 s2, 256
  s_cbranch_scc1 L_s1_end
  s_getpc_b64 s[60:61]
  v_lshlrev_b32 v2, 4, v0
  global_load_dwordx4 v[244:247], v2, s[60:61]
  v_add_u32 v3, 7168, v2
  global_load_dwordx4 v[244:247], v3, s[60:61]
  v_add_u32 v3, 14336, v2
  global_load_dwordx4 v[244:247], v3, s[60:61]
  v_add_u32 v3, 21504, v2
  global_load_dwordx4 v[244:247], v3, s[60:61]
  s_load_dwordx4 s[36:39], s[0:1], 0
  s_load_dwordx4 s[40:43], s[0:1], 32
  s_load_dwordx2 s[44:45], s[0:1], 64
  s_load_dwordx2 s[46:47], s[0:1], 88
  s_load_dwordx2 s[66:67], s[0:1], 16
  s_load_dwordx2 s[68:69], s[0:1], 48
  s_load_dwordx2 s[70:71], s[0:1], 80
  s_and_b32 s48, s2, 7
  s_lshr_b32 s49, s2, 3
  s_and_b32 s50, s48, 1
  s_lshl_b32 s50, s50, 3
  s_and_b32 s51, s49, 7
  s_add_u32 s32, s50, s51
  s_lshr_b32 s50, s48, 1
  s_lshl_b32 s50, s50, 1
  s_lshr_b32 s51, s49, 3
  s_lshr_b32 s34, s51, 1
  s_and_b32 s51, s51, 1
  s_add_u32 s33, s50, s51
  v_and_b32 v1, 63, v0
  v_lshrrev_b32 v2, 6, v0
  s_nop 0
  v_readfirstlane_b32 s35, v2
  s_nop 3
  s_lshr_b32 s52, s35, 1
  s_and_b32 s53, s35, 1
  s_mov_b32 s57, 0
  s_mov_b32 s58, 0
  s_mov_b32 s59, 0
  s_waitcnt lgkmcnt(0)
  s_mov_b32 s8, s36
  s_and_b32 s9, s37, 0xffff
  s_mov_b32 s10, 0x280000
  s_mov_b32 s11, 0x00020000
  s_mov_b32 s12, s38
  s_and_b32 s13, s39, 0xffff
  s_mov_b32 s14, 0x258000
  s_mov_b32 s15, 0x00020000
  s_mov_b32 s16, s40
  s_and_b32 s17, s41, 0xffff
  s_mov_b32 s18, 0x1e0000
  s_mov_b32 s19, 0x00020000
  s_cmp_ge_u32 s35, 4
  s_cbranch_scc1 L_s1_now
  s_cmp_eq_u32 s34, 0
  s_cbranch_scc1 L_s1_nobias
  s_mov_b32 s24, s42
  s_and_b32 s25, s43, 0xffff
  s_mov_b32 s26, 0xc00
  s_mov_b32 s27, 0x00020000
  s_mul_i32 s63, s33, 384
  s_mul_i32 s64, s53, 192
  s_add_u32 s63, s63, s64
  v_lshrrev_b32 v3, 4, v1
  v_lshlrev_b32 v4, 3, v3
  buffer_load_dwordx2 v[32:33], v4, s[24:27], s63 offen offset:0
  buffer_load_dwordx2 v[34:35], v4, s[24:27], s63 offen offset:32
  buffer_load_dwordx2 v[36:37], v4, s[24:27], s63 offen offset:64
  buffer_load_dwordx2 v[38:39], v4, s[24:27], s63 offen offset:96
  buffer_load_dwordx2 v[40:41], v4, s[24:27], s63 offen offset:128
  buffer_load_dwordx2 v[42:43], v4, s[24:27], s63 offen offset:160
L_s1_nobias:
  v_lshlrev_b32 v2, 4, v1
  s_mul_i32 s60, s2, 10240
  s_mul_i32 s61, s35, 2560
  s_add_u32 s60, s60, s61
  buffer_load_dwordx4 v[240:243], v2, s[8:11], s60 offen offset:0
  buffer_load_dwordx4 v[240:243], v2, s[8:11], s60 offen offset:1024
  buffer_load_dwordx4 v[240:243], v2, s[8:11], s60 offen offset:2048
  s_mul_i32 s60, s2, 9600
  s_mul_i32 s61, s35, 2400
  s_add_u32 s60, s60, s61
  buffer_load_dwordx4 v[240:243], v2, s[12:15], s60 offen offset:0
  buffer_load_dwordx4 v[240:243], v2, s[12:15], s60 offen offset:1024
  buffer_load_dwordx4 v[240:243], v2, s[12:15], s60 offen offset:2048
  s_mul_i32 s60, s2, 7680
  s_mul_i32 s61, s35, 1920
  s_add_u32 s60, s60, s61
  buffer_load_dwordx4 v[240:243], v2, s[16:19], s60 offen offset:0
  buffer_load_dwordx4 v[240:243], v2, s[16:19], s60 offen offset:1024
L_s1_now:
  s_mov_b32 s20, s46
  s_and_b32 s21, s47, 0xffff
  s_mov_b32 s22, 0x1800000
  s_mov_b32 s23, 0x00020000
  s_mov_b32 s24, s42
  s_and_b32 s25, s43, 0xffff
  s_mov_b32 s26, 0xc00
  s_mov_b32 s27, 0x00020000
  s_mov_b32 s28, s44
  s_and_b32 s29, s45, 0xffff
  s_mov_b32 s30, 0x500
  s_mov_b32 s31, 0x00020000
  s_cmp_lt_u32 s35, 4
  s_cbranch_scc1 L_s1_compute
  s_cmp_eq_u32 s35, 4
  s_cbranch_scc1 L_s1_loader
  s_cmp_eq_u32 s35, 6
  s_cbranch_scc1 L_s1_aux
  v_lshrrev_b32 v2, 3, v1
  v_mul_u32_u24 v2, 1280, v2
  v_and_b32 v3, 7, v1
  v_lshrrev_b32 v4, 4, v1
  v_xor_b32 v5, v3, v4
  v_lshlrev_b32 v6, 4, v5
  v_add_u32 v96, v2, v6
  v_xor_b32 v5, 4, v5
  v_lshlrev_b32 v6, 4, v5
  v_add_u32 v97, v2, v6
  s_lshl_b32 s60, s32, 7
  s_mul_i32 s54, s60, 1280
L_s1_ld_X:
  s_add_u32 m0, s57, 0
  s_add_u32 s64, s54, 0
  buffer_load_dwordx4 v96, s[8:11], s64 offen lds
  s_add_u32 m0, s57, 1024
  s_add_u32 s64, s54, 10240
  buffer_load_dwordx4 v97, s[8:11], s64 offen lds
  s_add_u32 m0, s57, 2048
  s_add_u32 s64, s54, 20480
  buffer_load_dwordx4 v96, s[8:11], s64 offen lds
  s_add_u32 m0, s57, 3072
  s_add_u32 s64, s54, 30720
  buffer_load_dwordx4 v97, s[8:11], s64 offen lds
  s_add_u32 m0, s57, 4096
  s_add_u32 s64, s54, 40960
  buffer_load_dwordx4 v96, s[8:11], s64 offen lds
  s_add_u32 m0, s57, 5120
  s_add_u32 s64, s54, 51200
  buffer_load_dwordx4 v97, s[8:11], s64 offen lds
  s_add_u32 m0, s57, 6144
  s_add_u32 s64, s54, 61440
  buffer_load_dwordx4 v96, s[8:11], s64 offen lds
  s_add_u32 m0, s57, 7168
  s_add_u32 s64, s54, 71680
  buffer_load_dwordx4 v97, s[8:11], s64 offen lds
  s_add_u32 m0, s57, 8192
  s_add_u32 s64, s54, 81920
  buffer_load_dwordx4 v96, s[8:11], s64 offen lds
  s_add_u32 m0, s57, 9216
  s_add_u32 s64, s54, 92160
  buffer_load_dwordx4 v97, s[8:11], s64 offen lds
  s_add_u32 m0, s57, 10240
  s_add_u32 s64, s54, 102400
  buffer_load_dwordx4 v96, s[8:11], s64 offen lds
  s_add_u32 m0, s57, 11264
  s_add_u32 s64, s54, 112640
  buffer_load_dwordx4 v97, s[8:11], s64 offen lds
  s_add_u32 m0, s57, 12288
  s_add_u32 s64, s54, 122880
  buffer_load_dwordx4 v96, s[8:11], s64 offen lds
  s_add_u32 m0, s57, 13312
  s_add_u32 s64, s54, 133120
  buffer_load_dwordx4 v97, s[8:11], s64 offen lds
  s_add_u32 m0, s57, 14336
  s_add_u32 s64, s54, 143360
  buffer_load_dwordx4 v96, s[8:11], s64 offen lds
  s_add_u32 m0, s57, 15360
  s_add_u32 s64, s54, 153600
  buffer_load_dwordx4 v97, s[8:11], s64 offen lds
  s_add_u32 s54, s54, 128
  s_add_u32 s57, s57, 45056
  s_cmp_eq_u32 s57, 135168
  s_cselect_b32 s57, 0, s57
  s_add_u32 s59, s59, 1
  s_cmp_eq_u32 s59, 1
  s_cbranch_scc1 L_s1_ld_X
  s_waitcnt vmcnt(16)
  s_barrier
  s_cmp_lt_u32 s59, 10
  s_cbranch_scc1 L_s1_ld_X
  s_waitcnt vmcnt(0)
  s_barrier
  s_barrier
  s_endpgm
L_s1_loader:
  s_cmp_eq_u32 s34, 1
  s_cbranch_scc1 L_s1_loaderB
  s_mov_b32 s55, 0
  s_mov_b32 s56, 0
  s_mov_b32 s67, 153391690
  s_mul_i32 s68, s33, 160
  s_add_u32 s69, s68, 1280
  s_add_u32 s70, s68, 2400
  s_lshl_b32 s71, s33, 7
  s_sub_u32 s71, s71, 320
  v_mov_b32 v8, s69
  v_mov_b32 v9, s70
  v_mov_b32 v10, s71
  v_add_u32 v2, 0, v1
  v_mul_hi_u32 v3, v2, s67
  v_mul_u32_u24 v4, 28, v3
  v_sub_u32 v4, v2, v4
  v_and_b32 v5, 4, v3
  v_lshrrev_b32 v5, 1, v5
  v_xor_b32 v4, v4, v5
  v_cmp_gt_u32 vcc, 10, v4
  v_cmp_gt_u32 s[72:73], 20, v4
  v_and_b32 v5, 3, v3
  v_and_b32 v6, 4, v3
  v_lshlrev_b32 v6, 1, v6
  v_or_b32 v5, v5, v6
  v_and_b32 v6, 8, v3
  v_lshrrev_b32 v6, 1, v6
  v_or_b32 v5, v5, v6
  v_mul_u32_u24 v5, 3840, v5
  v_cndmask_b32 v6, v9, v8, vcc
  v_cndmask_b32 v6, v10, v6, s[72:73]
  v_lshlrev_b32 v4, 4, v4
  v_add3_u32 v98, v5, v6, v4
  v_add_u32 v2, 64, v1
  v_mul_hi_u32 v3, v2, s67
  v_mul_u32_u24 v4, 28, v3
  v_sub_u32 v4, v2, v4
  v_and_b32 v5, 4, v3
  v_lshrrev_b32 v5, 1, v5
  v_xor_b32 v4, v4, v5
  v_cmp_gt_u32 vcc, 10, v4
  v_cmp_gt_u32 s[72:73], 20, v4
  v_and_b32 v5, 3, v3
  v_and_b32 v6, 4, v3
  v_lshlrev_b32 v6, 1, v6
  v_or_b32 v5, v5, v6
  v_and_b32 v6, 8, v3
  v_lshrrev_b32 v6, 1, v6
  v_or_b32 v5, v5, v6
  v_mul_u32_u24 v5, 3840, v5
  v_cndmask_b32 v6, v9, v8, vcc
  v_cndmask_b32 v6, v10, v6, s[72:73]
  v_lshlrev_b32 v4, 4, v4
  v_add3_u32 v99, v5, v6, v4
  v_add_u32 v2, 128, v1
  v_mul_hi_u32 v3, v2, s67
  v_mul_u32_u24 v4, 28, v3
  v_sub_u32 v4, v2, v4
  v_and_b32 v5, 4, v3
  v_lshrrev_b32 v5, 1, v5
  v_xor_b32 v4, v4, v5
  v_cmp_gt_u32 vcc, 10, v4
  v_cmp_gt_u32 s[72:73], 20, v4
  v_and_b32 v5, 3, v3
  v_and_b32 v6, 4, v3
  v_lshlrev_b32 v6, 1, v6
  v_or_b32 v5, v5, v6
  v_and_b32 v6, 8, v3
  v_lshrrev_b32 v6, 1, v6
  v_or_b32 v5, v5, v6
  v_mul_u32_u24 v5, 3840, v5
  v_cndmask_b32 v6, v9, v8, vcc
  v_cndmask_b32 v6, v10, v6, s[72:73]
  v_lshlrev_b32 v4, 4, v4
  v_add3_u32 v100, v5, v6, v4
  v_add_u32 v2, 192, v1
  v_mul_hi_u32 v3, v2, s67
  v_mul_u32_u24 v4, 28, v3
  v_sub_u32 v4, v2, v4
  v_and_b32 v5, 4, v3
  v_lshrrev_b32 v5, 1, v5
  v_xor_b32 v4, v4, v5
  v_cmp_gt_u32 vcc, 10, v4
  v_cmp_gt_u32 s[72:73], 20, v4
  v_and_b32 v5, 3, v3
  v_and_b32 v6, 4, v3
  v_lshlrev_b32 v6, 1, v6
  v_or_b32 v5, v5, v6
  v_and_b32 v6, 8, v3
  v_lshrrev_b32 v6, 1, v6
  v_or_b32 v5, v5, v6
  v_mul_u32_u24 v5, 3840, v5
  v_cndmask_b32 v6, v9, v8, vcc
  v_cndmask_b32 v6, v10, v6, s[72:73]
  v_lshlrev_b32 v4, 4, v4
  v_add3_u32 v101, v5, v6, v4
  v_add_u32 v2, 256, v1
  v_mul_hi_u32 v3, v2, s67
  v_mul_u32_u24 v4, 28, v3
  v_sub_u32 v4, v2, v4
  v_and_b32 v5, 4, v3
  v_lshrrev_b32 v5, 1, v5
  v_xor_b32 v4, v4, v5
  v_cmp_gt_u32 vcc, 10, v4
  v_cmp_gt_u32 s[72:73], 20, v4
  v_and_b32 v5, 3, v3
  v_and_b32 v6, 4, v3
  v_lshlrev_b32 v6, 1, v6
  v_or_b32 v5, v5, v6
  v_and_b32 v6, 8, v3
  v_lshrrev_b32 v6, 1, v6
  v_or_b32 v5, v5, v6
  v_mul_u32_u24 v5, 3840, v5
  v_cndmask_b32 v6, v9, v8, vcc
  v_cndmask_b32 v6, v10, v6, s[72:73]
  v_lshlrev_b32 v4, 4, v4
  v_add3_u32 v102, v5, v6, v4
  v_add_u32 v2, 320, v1
  v_mul_hi_u32 v3, v2, s67
  v_mul_u32_u24 v4, 28, v3
  v_sub_u32 v4, v2, v4
  v_and_b32 v5, 4, v3
  v_lshrrev_b32 v5, 1, v5
  v_xor_b32 v4, v4, v5
  v_cmp_gt_u32 vcc, 10, v4
  v_cmp_gt_u32 s[72:73], 20, v4
  v_and_b32 v5, 3, v3
  v_and_b32 v6, 4, v3
  v_lshlrev_b32 v6, 1, v6
  v_or_b32 v5, v5, v6
  v_and_b32 v6, 8, v3
  v_lshrrev_b32 v6, 1, v6
  v_or_b32 v5, v5, v6
  v_mul_u32_u24 v5, 3840, v5
  v_cndmask_b32 v6, v9, v8, vcc
  v_cndmask_b32 v6, v10, v6, s[72:73]
  v_lshlrev_b32 v4, 4, v4
  v_add3_u32 v103, v5, v6, v4
  v_add_u32 v2, 384, v1
  v_mul_hi_u32 v3, v2, s67
  v_mul_u32_u24 v4, 28, v3
  v_sub_u32 v4, v2, v4
  v_and_b32 v5, 4, v3
  v_lshrrev_b32 v5, 1, v5
  v_xor_b32 v4, v4, v5
  v_cmp_gt_u32 vcc, 10, v4
  v_cmp_gt_u32 s[72:73], 20, v4
  v_and_b32 v5, 3, v3
  v_and_b32 v6, 4, v3
  v_lshlrev_b32 v6, 1, v6
  v_or_b32 v5, v5, v6
  v_and_b32 v6, 8, v3
  v_lshrrev_b32 v6, 1, v6
  v_or_b32 v5, v5, v6
  v_mul_u32_u24 v5, 3840, v5
  v_cndmask_b32 v6, v9, v8, vcc
  v_cndmask_b32 v6, v10, v6, s[72:73]
  v_lshlrev_b32 v4, 4, v4
  v_add3_u32 v104, v5, v6, v4
L_s1_ld_A:
  s_add_u32 m0, s57, 16384
  s_add_u32 s64, s55, 0
  buffer_load_dwordx4 v98, s[12:15], s64 offen lds
  s_add_u32 m0, s57, 17408
  s_add_u32 s64, s55, 0
  buffer_load_dwordx4 v99, s[12:15], s64 offen lds
  s_add_u32 m0, s57, 18432
  s_add_u32 s64, s55, 0
  buffer_load_dwordx4 v100, s[12:15], s64 offen lds
  s_add_u32 m0, s57, 19456
  s_add_u32 s64, s55, 0
  buffer_load_dwordx4 v101, s[12:15], s64 offen lds
  s_add_u32 m0, s57, 20480
  s_add_u32 s64, s55, 0
  buffer_load_dwordx4 v102, s[12:15], s64 offen lds
  s_add_u32 m0, s57, 21504
  s_add_u32 s64, s55, 0
  buffer_load_dwordx4 v103, s[12:15], s64 offen lds
  s_add_u32 m0, s57, 22528
  s_add_u32 s64, s55, 0
  buffer_load_dwordx4 v104, s[12:15], s64 offen lds
  s_add_u32 m0, s57, 23552
  s_add_u32 s64, s55, 61440
  buffer_load_dwordx4 v98, s[12:15], s64 offen lds
  s_add_u32 m0, s57, 24576
  s_add_u32 s64, s55, 61440
  buffer_load_dwordx4 v99, s[12:15], s64 offen lds
  s_add_u32 m0, s57, 25600
  s_add_u32 s64, s55, 61440
  buffer_load_dwordx4 v100, s[12:15], s64 offen lds
  s_add_u32 m0, s57, 26624
  s_add_u32 s64, s55, 61440
  buffer_load_dwordx4 v101, s[12:15], s64 offen lds
  s_add_u32 m0, s57, 27648
  s_add_u32 s64, s55, 61440
  buffer_load_dwordx4 v102, s[12:15], s64 offen lds
  s_add_u32 m0, s57, 28672
  s_add_u32 s64, s55, 61440
  buffer_load_dwordx4 v103, s[12:15], s64 offen lds
  s_add_u32 m0, s57, 29696
  s_add_u32 s64, s55, 61440
  buffer_load_dwordx4 v104, s[12:15], s64 offen lds
  s_add_u32 m0, s57, 30720
  s_add_u32 s64, s55, 122880
  buffer_load_dwordx4 v98, s[12:15], s64 offen lds
  s_add_u32 m0, s57, 31744
  s_add_u32 s64, s55, 122880
  buffer_load_dwordx4 v99, s[12:15], s64 offen lds
  s_add_u32 m0, s57, 32768
  s_add_u32 s64, s55, 122880
  buffer_load_dwordx4 v100, s[12:15], s64 offen lds
  s_add_u32 m0, s57, 33792
  s_add_u32 s64, s55, 122880
  buffer_load_dwordx4 v101, s[12:15], s64 offen lds
  s_add_u32 m0, s57, 34816
  s_add_u32 s64, s55, 122880
  buffer_load_dwordx4 v102, s[12:15], s64 offen lds
  s_add_u32 m0, s57, 35840
  s_add_u32 s64, s55, 122880
  buffer_load_dwordx4 v103, s[12:15], s64 offen lds
  s_add_u32 m0, s57, 36864
  s_add_u32 s64, s55, 122880
  buffer_load_dwordx4 v104, s[12:15], s64 offen lds
  s_add_u32 m0, s57, 37888
  s_add_u32 s64, s55, 184320
  buffer_load_dwordx4 v98, s[12:15], s64 offen lds
  s_add_u32 m0, s57, 38912
  s_add_u32 s64, s55, 184320
  buffer_load_dwordx4 v99, s[12:15], s64 offen lds
  s_add_u32 m0, s57, 39936
  s_add_u32 s64, s55, 184320
  buffer_load_dwordx4 v100, s[12:15], s64 offen lds
  s_add_u32 m0, s57, 40960
  s_add_u32 s64, s55, 184320
  buffer_load_dwordx4 v101, s[12:15], s64 offen lds
  s_add_u32 m0, s57, 41984
  s_add_u32 s64, s55, 184320
  buffer_load_dwordx4 v102, s[12:15], s64 offen lds
  s_add_u32 m0, s57, 43008
  s_add_u32 s64, s55, 184320
  buffer_load_dwordx4 v103, s[12:15], s64 offen lds
  s_add_u32 m0, s57, 44032
  s_add_u32 s64, s55, 184320
  buffer_load_dwordx4 v104, s[12:15], s64 offen lds
  s_add_u32 s55, s55, 245760
  s_add_u32 s57, s57, 45056
  s_cmp_eq_u32 s57, 135168
  s_cselect_b32 s57, 0, s57
  s_add_u32 s59, s59, 1
  s_cmp_eq_u32 s59, 1
  s_cbranch_scc1 L_s1_ld_A
  s_waitcnt vmcnt(28)
  s_barrier
  s_cmp_lt_u32 s59, 10
  s_cbranch_scc1 L_s1_ld_A
  s_waitcnt vmcnt(0)
  s_barrier
  s_barrier
  s_endpgm
L_s1_loaderB:
  s_mov_b32 s55, 0
  s_mov_b32 s56, 0
  s_mov_b32 s67, 178956971
  s_mul_i32 s68, s33, 384
  v_add_u32 v2, 0, v1
  v_mul_hi_u32 v3, v2, s67
  v_mul_u32_u24 v4, 24, v3
  v_sub_u32 v4, v2, v4
  v_and_b32 v5, 6, v3
  v_xor_b32 v4, v4, v5
  v_and_b32 v5, 3, v3
  v_and_b32 v6, 4, v3
  v_lshlrev_b32 v6, 1, v6
  v_or_b32 v5, v5, v6
  v_and_b32 v6, 8, v3
  v_lshrrev_b32 v6, 1, v6
  v_or_b32 v5, v5, v6
  v_mul_u32_u24 v5, 3072, v5
  v_lshlrev_b32 v4, 4, v4
  v_add3_u32 v98, v5, s68, v4
  v_add_u32 v2, 64, v1
  v_mul_hi_u32 v3, v2, s67
  v_mul_u32_u24 v4, 24, v3
  v_sub_u32 v4, v2, v4
  v_and_b32 v5, 6, v3
  v_xor_b32 v4, v4, v5
  v_and_b32 v5, 3, v3
  v_and_b32 v6, 4, v3
  v_lshlrev_b32 v6, 1, v6
  v_or_b32 v5, v5, v6
  v_and_b32 v6, 8, v3
  v_lshrrev_b32 v6, 1, v6
  v_or_b32 v5, v5, v6
  v_mul_u32_u24 v5, 3072, v5
  v_lshlrev_b32 v4, 4, v4
  v_add3_u32 v99, v5, s68, v4
  v_add_u32 v2, 128, v1
  v_mul_hi_u32 v3, v2, s67
  v_mul_u32_u24 v4, 24, v3
  v_sub_u32 v4, v2, v4
  v_and_b32 v5, 6, v3
  v_xor_b32 v4, v4, v5
  v_and_b32 v5, 3, v3
  v_and_b32 v6, 4, v3
  v_lshlrev_b32 v6, 1, v6
  v_or_b32 v5, v5, v6
  v_and_b32 v6, 8, v3
  v_lshrrev_b32 v6, 1, v6
  v_or_b32 v5, v5, v6
  v_mul_u32_u24 v5, 3072, v5
  v_lshlrev_b32 v4, 4, v4
  v_add3_u32 v100, v5, s68, v4
  v_add_u32 v2, 192, v1
  v_mul_hi_u32 v3, v2, s67
  v_mul_u32_u24 v4, 24, v3
  v_sub_u32 v4, v2, v4
  v_and_b32 v5, 6, v3
  v_xor_b32 v4, v4, v5
  v_and_b32 v5, 3, v3
  v_and_b32 v6, 4, v3
  v_lshlrev_b32 v6, 1, v6
  v_or_b32 v5, v5, v6
  v_and_b32 v6, 8, v3
  v_lshrrev_b32 v6, 1, v6
  v_or_b32 v5, v5, v6
  v_mul_u32_u24 v5, 3072, v5
  v_lshlrev_b32 v4, 4, v4
  v_add3_u32 v101, v5, s68, v4
  v_add_u32 v2, 256, v1
  v_mul_hi_u32 v3, v2, s67
  v_mul_u32_u24 v4, 24, v3
  v_sub_u32 v4, v2, v4
  v_and_b32 v5, 6, v3
  v_xor_b32 v4, v4, v5
  v_and_b32 v5, 3, v3
  v_and_b32 v6, 4, v3
  v_lshlrev_b32 v6, 1, v6
  v_or_b32 v5, v5, v6
  v_and_b32 v6, 8, v3
  v_lshrrev_b32 v6, 1, v6
  v_or_b32 v5, v5, v6
  v_mul_u32_u24 v5, 3072, v5
  v_lshlrev_b32 v4, 4, v4
  v_add3_u32 v102, v5, s68, v4
  v_add_u32 v2, 320, v1
  v_mul_hi_u32 v3, v2, s67
  v_mul_u32_u24 v4, 24, v3
  v_sub_u32 v4, v2, v4
  v_and_b32 v5, 6, v3
  v_xor_b32 v4, v4, v5
  v_and_b32 v5, 3, v3
  v_and_b32 v6, 4, v3
  v_lshlrev_b32 v6, 1, v6
  v_or_b32 v5, v5, v6
  v_and_b32 v6, 8, v3
  v_lshrrev_b32 v6, 1, v6
  v_or_b32 v5, v5, v6
  v_mul_u32_u24 v5, 3072, v5
  v_lshlrev_b32 v4, 4, v4
  v_add3_u32 v103, v5, s68, v4
  v_lshrrev_b32 v2, 1, v1
  v_and_b32 v3, 15, v2
  v_and_b32 v5, 3, v3
  v_and_b32 v6, 4, v3
  v_lshlrev_b32 v6, 1, v6
  v_or_b32 v5, v5, v6
  v_and_b32 v6, 8, v3
  v_lshrrev_b32 v6, 1, v6
  v_or_b32 v5, v5, v6
  v_and_b32 v3, 16, v2
  v_add_u32 v5, v5, v3
  v_mul_u32_u24 v5, 3840, v5
  v_and_b32 v4, 1, v1
  v_lshlrev_b32 v4, 4, v4
  s_lshl_b32 s68, s33, 5
  s_add_u32 s68, s68, 1024
  v_add3_u32 v104, v5, s68, v4
L_s1_ld_B:
  s_add_u32 m0, s57, 16384
  s_add_u32 s64, s56, 0
  buffer_load_dwordx4 v98, s[16:19], s64 offen lds
  s_add_u32 m0, s57, 17408
  s_add_u32 s64, s56, 0
  buffer_load_dwordx4 v99, s[16:19], s64 offen lds
  s_add_u32 m0, s57, 18432
  s_add_u32 s64, s56, 0
  buffer_load_dwordx4 v100, s[16:19], s64 offen lds
  s_add_u32 m0, s57, 19456
  s_add_u32 s64, s56, 0
  buffer_load_dwordx4 v101, s[16:19], s64 offen lds
  s_add_u32 m0, s57, 20480
  s_add_u32 s64, s56, 0
  buffer_load_dwordx4 v102, s[16:19], s64 offen lds
  s_add_u32 m0, s57, 21504
  s_add_u32 s64, s56, 0
  buffer_load_dwordx4 v103, s[16:19], s64 offen lds
  s_add_u32 m0, s57, 22528
  s_add_u32 s64, s56, 49152
  buffer_load_dwordx4 v98, s[16:19], s64 offen lds
  s_add_u32 m0, s57, 23552
  s_add_u32 s64, s56, 49152
  buffer_load_dwordx4 v99, s[16:19], s64 offen lds
  s_add_u32 m0, s57, 24576
  s_add_u32 s64, s56, 49152
  buffer_load_dwordx4 v100, s[16:19], s64 offen lds
  s_add_u32 m0, s57, 25600
  s_add_u32 s64, s56, 49152
  buffer_load_dwordx4 v101, s[16:19], s64 offen lds
  s_add_u32 m0, s57, 26624
  s_add_u32 s64, s56, 49152
  buffer_load_dwordx4 v102, s[16:19], s64 offen lds
  s_add_u32 m0, s57, 27648
  s_add_u32 s64, s56, 49152
  buffer_load_dwordx4 v103, s[16:19], s64 offen lds
  s_add_u32 m0, s57, 28672
  s_add_u32 s64, s56, 98304
  buffer_load_dwordx4 v98, s[16:19], s64 offen lds
  s_add_u32 m0, s57, 29696
  s_add_u32 s64, s56, 98304
  buffer_load_dwordx4 v99, s[16:19], s64 offen lds
  s_add_u32 m0, s57, 30720
  s_add_u32 s64, s56, 98304
  buffer_load_dwordx4 v100, s[16:19], s64 offen lds
  s_add_u32 m0, s57, 31744
  s_add_u32 s64, s56, 98304
  buffer_load_dwordx4 v101, s[16:19], s64 offen lds
  s_add_u32 m0, s57, 32768
  s_add_u32 s64, s56, 98304
  buffer_load_dwordx4 v102, s[16:19], s64 offen lds
  s_add_u32 m0, s57, 33792
  s_add_u32 s64, s56, 98304
  buffer_load_dwordx4 v103, s[16:19], s64 offen lds
  s_add_u32 m0, s57, 34816
  s_add_u32 s64, s56, 147456
  buffer_load_dwordx4 v98, s[16:19], s64 offen lds
  s_add_u32 m0, s57, 35840
  s_add_u32 s64, s56, 147456
  buffer_load_dwordx4 v99, s[16:19], s64 offen lds
  s_add_u32 m0, s57, 36864
  s_add_u32 s64, s56, 147456
  buffer_load_dwordx4 v100, s[16:19], s64 offen lds
  s_add_u32 m0, s57, 37888
  s_add_u32 s64, s56, 147456
  buffer_load_dwordx4 v101, s[16:19], s64 offen lds
  s_add_u32 m0, s57, 38912
  s_add_u32 s64, s56, 147456
  buffer_load_dwordx4 v102, s[16:19], s64 offen lds
  s_add_u32 m0, s57, 39936
  s_add_u32 s64, s56, 147456
  buffer_load_dwordx4 v103, s[16:19], s64 offen lds
  s_add_u32 m0, s57, 40960
  s_add_u32 s64, s55, 0
  buffer_load_dwordx4 v104, s[12:15], s64 offen lds
  s_add_u32 m0, s57, 41984
  s_add_u32 s64, s55, 122880
  buffer_load_dwordx4 v104, s[12:15], s64 offen lds
  s_add_u32 s55, s55, 245760
  s_add_u32 s56, s56, 196608
  s_add_u32 s57, s57, 45056
  s_cmp_eq_u32 s57, 135168
  s_cselect_b32 s57, 0, s57
  s_add_u32 s59, s59, 1
  s_cmp_eq_u32 s59, 1
  s_cbranch_scc1 L_s1_ld_B
  s_waitcnt vmcnt(26)
  s_barrier
  s_cmp_lt_u32 s59, 10
  s_cbranch_scc1 L_s1_ld_B
  s_waitcnt vmcnt(0)
  s_barrier
  s_barrier
  s_endpgm
L_s1_aux:
  v_lshlrev_b32 v2, 4, v1
  s_getpc_b64 s[60:61]
L_s1_pc:
  s_sub_u32 s60, s60, L_s1_pc-s1_kernel
  s_subb_u32 s61, s61, 0
  s_lshl_b32 s62, s49, 10
  v_add_u32 v3, s62, v2
  global_load_dwordx4 v[100:103], v3, s[60:61]
  s_add_u32 s62, s62, 32768
  s_cmp_ge_u32 s62, L_code_end-s1_kernel-1024
  s_cbranch_scc1 L_s1_nopf2
  v_add_u32 v3, s62, v2
  global_load_dwordx4 v[100:103], v3, s[60:61]
L_s1_nopf2:
  s_mov_b32 m0, 147456
  s_nop 0
  buffer_load_dwordx4 v2, s[28:31], 0 offen lds
  buffer_load_dwordx4 v2, s[28:31], 0 offen offset:1024 lds
  s_cmp_ge_u32 s2, 48
  s_cbranch_scc1 L_s1_noz
  v_pk_mov_b32 v[8:9], -1, -1
  v_pk_mov_b32 v[10:11], -1, -1
  s_lshl_b32 s60, s2, 10
  s_add_u32 s60, s60, 0xa00000
  buffer_store_dwordx4 v[8:11], v2, s[20:23], s60 offen
L_s1_noz:
  s_waitcnt vmcnt(0)
  s_barrier
  s_mov_b32 s72, s68
  s_and_b32 s73, s69, 0xffff
  s_mov_b32 s74, 0x1e0000
  s_mov_b32 s75, 0x00020000
  s_mov_b32 s76, s66
  s_and_b32 s77, s67, 0xffff
  s_mov_b32 s78, 0xc8000
  s_mov_b32 s79, 0x00020000
  v_lshrrev_b32 v2, 3, v1
  v_and_b32 v4, 7, v1
  v_lshrrev_b32 v5, 4, v1
  v_lshlrev_b32 v5, 1, v5
  v_xor_b32 v6, v4, v5
  v_lshlrev_b32 v6, 4, v6
  v_and_b32 v3, 3, v2
  v_lshrrev_b32 v4, 2, v2
  v_lshlrev_b32 v5, 3, v4
  v_add_u32 v5, v5, v3
  v_mul_u32_u24 v5, 1280, v5
  v_add_u32 v7, v5, v6
  v_mul_u32_u24 v5, 1280, v2
  v_add_u32 v8, v5, v6
  v_mul_u32_u24 v5, 20, v4
  v_add_u32 v5, v5, v3
  v_mul_u32_u24 v5, 1280, v5
  v_add_u32 v9, v5, v6
  s_mul_i32 s60, s2, 3
  s_add_u32 s60, s60, 0
  s_mov_b32 s82, -1
  s_cmp_ge_u32 s60, 680
  s_cbranch_scc1 L_s1_tr_done0
  s_cmp_ge_u32 s60, 480
  s_cbranch_scc1 L_s1_tr_wo0
  s_mul_i32 s62, s60, 6554
  s_lshr_b32 s62, s62, 16
  s_mul_i32 s63, s62, 10
  s_sub_u32 s63, s60, s63
  s_mul_i32 s70, s62, 40960
  s_lshl_b32 s71, s63, 7
  s_add_u32 s70, s70, s71
  s_mul_i32 s71, s62, 40
  s_lshl_b32 s63, s63, 2
  s_add_u32 s71, s71, s63
  s_lshl_b32 s71, s71, 10
  s_add_u32 s82, s71, 0xc00000
  s_mov_b32 m0, 135168
  s_add_u32 s64, s70, 0
  buffer_load_dwordx4 v7, s[72:75], s64 offen lds
  s_mov_b32 m0, 136192
  s_add_u32 s64, s70, 5120
  buffer_load_dwordx4 v7, s[72:75], s64 offen lds
  s_mov_b32 m0, 137216
  s_add_u32 s64, s70, 20480
  buffer_load_dwordx4 v7, s[72:75], s64 offen lds
  s_mov_b32 m0, 138240
  s_add_u32 s64, s70, 25600
  buffer_load_dwordx4 v7, s[72:75], s64 offen lds
  s_branch L_s1_tr_done0
L_s1_tr_wo0:
  s_sub_u32 s60, s60, 480
  s_mul_i32 s62, s60, 6554
  s_lshr_b32 s62, s62, 16
  s_mul_i32 s63, s62, 10
  s_sub_u32 s63, s60, s63
  s_mul_i32 s71, s62, 40
  s_lshl_b32 s64, s63, 2
  s_add_u32 s71, s71, s64
  s_lshl_b32 s71, s71, 10
  s_add_u32 s82, s71, 0xe00000
  s_mul_i32 s64, s62, 13108
  s_lshr_b32 s64, s64, 16
  s_mul_i32 s70, s64, 5
  s_sub_u32 s62, s62, s70
  s_mul_i32 s70, s64, 204800
  s_lshl_b32 s63, s63, 7
  s_add_u32 s70, s70, s63
  s_cmp_eq_u32 s62, 4
  s_cbranch_scc1 L_s1_tr_wl0
  s_mul_i32 s62, s62, 51200
  s_add_u32 s70, s70, s62
  s_mov_b32 m0, 135168
  s_add_u32 s64, s70, 0
  buffer_load_dwordx4 v8, s[76:79], s64 offen lds
  s_mov_b32 m0, 136192
  s_add_u32 s64, s70, 25600
  buffer_load_dwordx4 v8, s[76:79], s64 offen lds
  s_mov_b32 m0, 137216
  s_add_u32 s64, s70, 10240
  buffer_load_dwordx4 v8, s[76:79], s64 offen lds
  s_mov_b32 m0, 138240
  s_add_u32 s64, s70, 35840
  buffer_load_dwordx4 v8, s[76:79], s64 offen lds
  s_branch L_s1_tr_done0
L_s1_tr_wl0:
  s_mov_b32 m0, 135168
  s_add_u32 s64, s70, 20480
  buffer_load_dwordx4 v9, s[76:79], s64 offen lds
  s_mov_b32 m0, 136192
  s_add_u32 s64, s70, 122880
  buffer_load_dwordx4 v9, s[76:79], s64 offen lds
  s_mov_b32 m0, 137216
  s_add_u32 s64, s70, 71680
  buffer_load_dwordx4 v9, s[76:79], s64 offen lds
  s_mov_b32 m0, 138240
  s_add_u32 s64, s70, 174080
  buffer_load_dwordx4 v9, s[76:79], s64 offen lds
L_s1_tr_done0:
  s_mul_i32 s60, s2, 3
  s_add_u32 s60, s60, 1
  s_mov_b32 s83, -1
  s_cmp_ge_u32 s60, 680
  s_cbranch_scc1 L_s1_tr_done1
  s_cmp_ge_u32 s60, 480
  s_cbranch_scc1 L_s1_tr_wo1
  s_mul_i32 s62, s60, 6554
  s_lshr_b32 s62, s62, 16
  s_mul_i32 s63, s62, 10
  s_sub_u32 s63, s60, s63
  s_mul_i32 s70, s62, 40960
  s_lshl_b32 s71, s63, 7
  s_add_u32 s70, s70, s71
  s_mul_i32 s71, s62, 40
  s_lshl_b32 s63, s63, 2
  s_add_u32 s71, s71, s63
  s_lshl_b32 s71, s71, 10
  s_add_u32 s83, s71, 0xc00000
  s_mov_b32 m0, 139264
  s_add_u32 s64, s70, 0
  buffer_load_dwordx4 v7, s[72:75], s64 offen lds
  s_mov_b32 m0, 140288
  s_add_u32 s64, s70, 5120
  buffer_load_dwordx4 v7, s[72:75], s64 offen lds
  s_mov_b32 m0, 141312
  s_add_u32 s64, s70, 20480
  buffer_load_dwordx4 v7, s[72:75], s64 offen lds
  s_mov_b32 m0, 142336
  s_add_u32 s64, s70, 25600
  buffer_load_dwordx4 v7, s[72:75], s64 offen lds
  s_branch L_s1_tr_done1
L_s1_tr_wo1:
  s_sub_u32 s60, s60, 480
  s_mul_i32 s62, s60, 6554
  s_lshr_b32 s62, s62, 16
  s_mul_i32 s63, s62, 10
  s_sub_u32 s63, s60, s63
  s_mul_i32 s71, s62, 40
  s_lshl_b32 s64, s63, 2
  s_add_u32 s71, s71, s64
  s_lshl_b32 s71, s71, 10
  s_add_u32 s83, s71, 0xe00000
  s_mul_i32 s64, s62, 13108
  s_lshr_b32 s64, s64, 16
  s_mul_i32 s70, s64, 5
  s_sub_u32 s62, s62, s70
  s_mul_i32 s70, s64, 204800
  s_lshl_b32 s63, s63, 7
  s_add_u32 s70, s70, s63
  s_cmp_eq_u32 s62, 4
  s_cbranch_scc1 L_s1_tr_wl1
  s_mul_i32 s62, s62, 51200
  s_add_u32 s70, s70, s62
  s_mov_b32 m0, 139264
  s_add_u32 s64, s70, 0
  buffer_load_dwordx4 v8, s[76:79], s64 offen lds
  s_mov_b32 m0, 140288
  s_add_u32 s64, s70, 25600
  buffer_load_dwordx4 v8, s[76:79], s64 offen lds
  s_mov_b32 m0, 141312
  s_add_u32 s64, s70, 10240
  buffer_load_dwordx4 v8, s[76:79], s64 offen lds
  s_mov_b32 m0, 142336
  s_add_u32 s64, s70, 35840
  buffer_load_dwordx4 v8, s[76:79], s64 offen lds
  s_branch L_s1_tr_done1
L_s1_tr_wl1:
  s_mov_b32 m0, 139264
  s_add_u32 s64, s70, 20480
  buffer_load_dwordx4 v9, s[76:79], s64 offen lds
  s_mov_b32 m0, 140288
  s_add_u32 s64, s70, 122880
  buffer_load_dwordx4 v9, s[76:79], s64 offen lds
  s_mov_b32 m0, 141312
  s_add_u32 s64, s70, 71680
  buffer_load_dwordx4 v9, s[76:79], s64 offen lds
  s_mov_b32 m0, 142336
  s_add_u32 s64, s70, 174080
  buffer_load_dwordx4 v9, s[76:79], s64 offen lds
L_s1_tr_done1:
  s_mul_i32 s60, s2, 3
  s_add_u32 s60, s60, 2
  s_mov_b32 s84, -1
  s_cmp_ge_u32 s60, 680
  s_cbranch_scc1 L_s1_tr_done2
  s_cmp_ge_u32 s60, 480
  s_cbranch_scc1 L_s1_tr_wo2
  s_mul_i32 s62, s60, 6554
  s_lshr_b32 s62, s62, 16
  s_mul_i32 s63, s62, 10
  s_sub_u32 s63, s60, s63
  s_mul_i32 s70, s62, 40960
  s_lshl_b32 s71, s63, 7
  s_add_u32 s70, s70, s71
  s_mul_i32 s71, s62, 40
  s_lshl_b32 s63, s63, 2
  s_add_u32 s71, s71, s63
  s_lshl_b32 s71, s71, 10
  s_add_u32 s84, s71, 0xc00000
  s_mov_b32 m0, 143360
  s_add_u32 s64, s70, 0
  buffer_load_dwordx4 v7, s[72:75], s64 offen lds
  s_mov_b32 m0, 144384
  s_add_u32 s64, s70, 5120
  buffer_load_dwordx4 v7, s[72:75], s64 offen lds
  s_mov_b32 m0, 145408
  s_add_u32 s64, s70, 20480
  buffer_load_dwordx4 v7, s[72:75], s64 offen lds
  s_mov_b32 m0, 146432
  s_add_u32 s64, s70, 25600
  buffer_load_dwordx4 v7, s[72:75], s64 offen lds
  s_branch L_s1_tr_done2
L_s1_tr_wo2:
  s_sub_u32 s60, s60, 480
  s_mul_i32 s62, s60, 6554
  s_lshr_b32 s62, s62, 16
  s_mul_i32 s63, s62, 10
  s_sub_u32 s63, s60, s63
  s_mul_i32 s71, s62, 40
  s_lshl_b32 s64, s63, 2
  s_add_u32 s71, s71, s64
  s_lshl_b32 s71, s71, 10
  s_add_u32 s84, s71, 0xe00000
  s_mul_i32 s64, s62, 13108
  s_lshr_b32 s64, s64, 16
  s_mul_i32 s70, s64, 5
  s_sub_u32 s62, s62, s70
  s_mul_i32 s70, s64, 204800
  s_lshl_b32 s63, s63, 7
  s_add_u32 s70, s70, s63
  s_cmp_eq_u32 s62, 4
  s_cbranch_scc1 L_s1_tr_wl2
  s_mul_i32 s62, s62, 51200
  s_add_u32 s70, s70, s62
  s_mov_b32 m0, 143360
  s_add_u32 s64, s70, 0
  buffer_load_dwordx4 v8, s[76:79], s64 offen lds
  s_mov_b32 m0, 144384
  s_add_u32 s64, s70, 25600
  buffer_load_dwordx4 v8, s[76:79], s64 offen lds
  s_mov_b32 m0, 145408
  s_add_u32 s64, s70, 10240
  buffer_load_dwordx4 v8, s[76:79], s64 offen lds
  s_mov_b32 m0, 146432
  s_add_u32 s64, s70, 35840
  buffer_load_dwordx4 v8, s[76:79], s64 offen lds
  s_branch L_s1_tr_done2
L_s1_tr_wl2:
  s_mov_b32 m0, 143360
  s_add_u32 s64, s70, 20480
  buffer_load_dwordx4 v9, s[76:79], s64 offen lds
  s_mov_b32 m0, 144384
  s_add_u32 s64, s70, 122880
  buffer_load_dwordx4 v9, s[76:79], s64 offen lds
  s_mov_b32 m0, 145408
  s_add_u32 s64, s70, 71680
  buffer_load_dwordx4 v9, s[76:79], s64 offen lds
  s_mov_b32 m0, 146432
  s_add_u32 s64, s70, 174080
  buffer_load_dwordx4 v9, s[76:79], s64 offen lds
L_s1_tr_done2:
  s_barrier
  s_barrier
  s_barrier
  s_waitcnt vmcnt(0)
  v_lshrrev_b32 v3, 4, v1
  v_lshrrev_b32 v4, 2, v1
  v_and_b32 v4, 3, v4
  v_and_b32 v5, 3, v1
  v_lshlrev_b32 v5, 3, v5
  v_lshrrev_b32 v6, 1, v3
  v_lshlrev_b32 v6, 4, v6
  v_and_b32 v7, 1, v3
  v_lshlrev_b32 v7, 2, v7
  v_add3_u32 v6, v6, v7, v4
  v_lshrrev_b32 v7, 1, v6
  v_and_b32 v7, 3, v7
  v_lshlrev_b32 v6, 7, v6
  v_add_u32 v6, v6, v5
  v_add_u32 v6, 135168, v6
  v_lshlrev_b32 v2, 4, v1
  v_xor_b32 v4, 0, v7
  v_lshl_add_u32 v10, v4, 5, v6
  v_xor_b32 v4, 1, v7
  v_lshl_add_u32 v11, v4, 5, v6
  v_xor_b32 v4, 2, v7
  v_lshl_add_u32 v12, v4, 5, v6
  v_xor_b32 v4, 3, v7
  v_lshl_add_u32 v13, v4, 5, v6
  ds_read_b64_tr_b16 v[104:105], v10 offset:0
  ds_read_b64_tr_b16 v[106:107], v10 offset:1024
  ds_read_b64_tr_b16 v[108:109], v11 offset:0
  ds_read_b64_tr_b16 v[110:111], v11 offset:1024
  ds_read_b64_tr_b16 v[112:113], v12 offset:0
  ds_read_b64_tr_b16 v[114:115], v12 offset:1024
  ds_read_b64_tr_b16 v[116:117], v13 offset:0
  ds_read_b64_tr_b16 v[118:119], v13 offset:1024
  ds_read_b64_tr_b16 v[120:121], v10 offset:4096
  ds_read_b64_tr_b16 v[122:123], v10 offset:5120
  ds_read_b64_tr_b16 v[124:125], v11 offset:4096
  ds_read_b64_tr_b16 v[126:127], v11 offset:5120
  ds_read_b64_tr_b16 v[128:129], v12 offset:4096
  ds_read_b64_tr_b16 v[130:131], v12 offset:5120
  ds_read_b64_tr_b16 v[132:133], v13 offset:4096
  ds_read_b64_tr_b16 v[134:135], v13 offset:5120
  ds_read_b64_tr_b16 v[136:137], v10 offset:8192
  ds_read_b64_tr_b16 v[138:139], v10 offset:9216
  ds_read_b64_tr_b16 v[140:141], v11 offset:8192
  ds_read_b64_tr_b16 v[142:143], v11 offset:9216
  ds_read_b64_tr_b16 v[144:145], v12 offset:8192
  ds_read_b64_tr_b16 v[146:147], v12 offset:9216
  ds_read_b64_tr_b16 v[148:149], v13 offset:8192
  ds_read_b64_tr_b16 v[150:151], v13 offset:9216
  s_waitcnt lgkmcnt(0)
  s_cmp_eq_u32 s82, -1
  s_cbranch_scc1 L_s1_tr_skip0
  buffer_store_dwordx4 v[104:107], v2, s[20:23], s82 offen offset:0
  buffer_store_dwordx4 v[108:111], v2, s[20:23], s82 offen offset:1024
  buffer_store_dwordx4 v[112:115], v2, s[20:23], s82 offen offset:2048
  buffer_store_dwordx4 v[116:119], v2, s[20:23], s82 offen offset:3072
L_s1_tr_skip0:
  s_cmp_eq_u32 s83, -1
  s_cbranch_scc1 L_s1_tr_skip1
  buffer_store_dwordx4 v[120:123], v2, s[20:23], s83 offen offset:0
  buffer_store_dwordx4 v[124:127], v2, s[20:23], s83 offen offset:1024
  buffer_store_dwordx4 v[128:131], v2, s[20:23], s83 offen offset:2048
  buffer_store_dwordx4 v[132:135], v2, s[20:23], s83 offen offset:3072
L_s1_tr_skip1:
  s_cmp_eq_u32 s84, -1
  s_cbranch_scc1 L_s1_tr_skip2
  buffer_store_dwordx4 v[136:139], v2, s[20:23], s84 offen offset:0
  buffer_store_dwordx4 v[140:143], v2, s[20:23], s84 offen offset:1024
  buffer_store_dwordx4 v[144:147], v2, s[20:23], s84 offen offset:2048
  buffer_store_dwordx4 v[148:151], v2, s[20:23], s84 offen offset:3072
L_s1_tr_skip2:
  s_barrier
  s_barrier
  s_barrier
  s_barrier
  s_barrier
  s_barrier
  s_barrier
  s_endpgm
L_s1_compute:
  s_mov_b32 s78, 0x3fb8aa3b
  s_mov_b32 s79, 0x3fb8aa3b
  s_mov_b32 s80, 0x358637bd
  s_mov_b32 s81, 0x358637bd
  v_and_b32 v2, 15, v1
  v_lshrrev_b32 v3, 4, v1
  s_lshl_b32 s60, s52, 6
  v_add_u32 v4, s60, v2
  v_lshlrev_b32 v4, 7, v4
  v_lshrrev_b32 v5, 1, v2
  v_xor_b32 v5, v5, v3
  v_lshlrev_b32 v6, 4, v5
  v_add_u32 v105, v4, v6
  v_xor_b32 v5, 4, v5
  v_lshlrev_b32 v6, 4, v5
  v_add_u32 v106, v4, v6
  v_lshrrev_b32 v4, 2, v1
  v_and_b32 v4, 3, v4
  v_and_b32 v5, 3, v1
  v_lshlrev_b32 v5, 3, v5
  v_lshrrev_b32 v6, 1, v3
  v_lshlrev_b32 v6, 4, v6
  v_and_b32 v7, 1, v3
  v_lshlrev_b32 v2, 2, v7
  v_add3_u32 v6, v6, v2, v4
  s_cmp_eq_u32 s34, 1
  s_cbranch_scc1 L_s1_typeB
  v_mul_u32_u24 v2, 448, v6
  v_add_u32 v2, v2, v5
  v_add_u32 v2, 16384, v2
  v_lshlrev_b32 v7, 5, v7
  v_add_u32 v107, v2, v7
  v_sub_u32 v108, v2, v7
  s_cmp_eq_u32 s53, 1
  s_cbranch_scc1 L_s1_A1
  v_pk_mov_b32 v[128:129], s[80:81], s[80:81] op_sel:[0,1]
  v_pk_mov_b32 v[130:131], s[80:81], s[80:81] op_sel:[0,1]
  v_pk_mov_b32 v[132:133], s[80:81], s[80:81] op_sel:[0,1]
  v_pk_mov_b32 v[134:135], s[80:81], s[80:81] op_sel:[0,1]
  v_pk_mov_b32 v[136:137], s[80:81], s[80:81] op_sel:[0,1]
  v_pk_mov_b32 v[138:139], s[80:81], s[80:81] op_sel:[0,1]
  v_pk_mov_b32 v[140:141], s[80:81], s[80:81] op_sel:[0,1]
  v_pk_mov_b32 v[142:143], s[80:81], s[80:81] op_sel:[0,1]
  v_pk_mov_b32 v[144:145], s[80:81], s[80:81] op_sel:[0,1]
  v_pk_mov_b32 v[146:147], s[80:81], s[80:81] op_sel:[0,1]
  v_pk_mov_b32 v[148:149], s[80:81], s[80:81] op_sel:[0,1]
  v_pk_mov_b32 v[150:151], s[80:81], s[80:81] op_sel:[0,1]
  v_pk_mov_b32 v[152:153], s[80:81], s[80:81] op_sel:[0,1]
  v_pk_mov_b32 v[154:155], s[80:81], s[80:81] op_sel:[0,1]
  v_pk_mov_b32 v[156:157], s[80:81], s[80:81] op_sel:[0,1]
  v_pk_mov_b32 v[158:159], s[80:81], s[80:81] op_sel:[0,1]
  v_pk_mov_b32 v[160:161], s[80:81], s[80:81] op_sel:[0,1]
  v_pk_mov_b32 v[162:163], s[80:81], s[80:81] op_sel:[0,1]
  v_pk_mov_b32 v[164:165], s[80:81], s[80:81] op_sel:[0,1]
  v_pk_mov_b32 v[166:167], s[80:81], s[80:81] op_sel:[0,1]
  v_pk_mov_b32 v[168:169], s[80:81], s[80:81] op_sel:[0,1]
  v_pk_mov_b32 v[170:171], s[80:81], s[80:81] op_sel:[0,1]
  v_pk_mov_b32 v[172:173], s[80:81], s[80:81] op_sel:[0,1]
  v_pk_mov_b32 v[174:175], s[80:81], s[80:81] op_sel:[0,1]
  v_pk_mov_b32 v[176:177], 0, 0
  v_pk_mov_b32 v[178:179], 0, 0
  v_pk_mov_b32 v[180:181], 0, 0
  v_pk_mov_b32 v[182:183], 0, 0
  v_pk_mov_b32 v[184:185], 0, 0
  v_pk_mov_b32 v[186:187], 0, 0
  v_pk_mov_b32 v[188:189], 0, 0
  v_pk_mov_b32 v[190:191], 0, 0
  v_pk_mov_b32 v[192:193], 0, 0
  v_pk_mov_b32 v[194:195], 0, 0
  v_pk_mov_b32 v[196:197], 0, 0
  v_pk_mov_b32 v[198:199], 0, 0
  v_pk_mov_b32 v[200:201], 0, 0
  v_pk_mov_b32 v[202:203], 0, 0
  v_pk_mov_b32 v[204:205], 0, 0
  v_pk_mov_b32 v[206:207], 0, 0
  v_pk_mov_b32 v[208:209], s[80:81], s[80:81] op_sel:[0,1]
  v_pk_mov_b32 v[210:211], s[80:81], s[80:81] op_sel:[0,1]
  v_pk_mov_b32 v[212:213], s[80:81], s[80:81] op_sel:[0,1]
  v_pk_mov_b32 v[214:215], s[80:81], s[80:81] op_sel:[0,1]
  v_pk_mov_b32 v[216:217], s[80:81], s[80:81] op_sel:[0,1]
  v_pk_mov_b32 v[218:219], s[80:81], s[80:81] op_sel:[0,1]
  v_pk_mov_b32 v[220:221], s[80:81], s[80:81] op_sel:[0,1]
  v_pk_mov_b32 v[222:223], s[80:81], s[80:81] op_sel:[0,1]
  v_pk_mov_b32 v[224:225], s[80:81], s[80:81] op_sel:[0,1]
  v_pk_mov_b32 v[226:227], s[80:81], s[80:81] op_sel:[0,1]
  v_pk_mov_b32 v[228:229], s[80:81], s[80:81] op_sel:[0,1]
  v_pk_mov_b32 v[230:231], s[80:81], s[80:81] op_sel:[0,1]
  v_pk_mov_b32 v[232:233], s[80:81], s[80:81] op_sel:[0,1]
  v_pk_mov_b32 v[234:235], s[80:81], s[80:81] op_sel:[0,1]
  v_pk_mov_b32 v[236:237], s[80:81], s[80:81] op_sel:[0,1]
  v_pk_mov_b32 v[238:239], s[80:81], s[80:81] op_sel:[0,1]
  v_add_u32 v112, s58, v105
  v_add_u32 v113, s58, v106
  v_add_u32 v114, s58, v107
  v_add_u32 v115, s58, v108
  s_barrier
  ds_read_b64_tr_b16 v[8:9], v114 offset:0
  ds_read_b64_tr_b16 v[10:11], v114 offset:3584
  ds_read_b128 v[64:67], v112 offset:0
  ds_read_b128 v[68:71], v112 offset:2048
  ds_read_b128 v[72:75], v112 offset:4096
  ds_read_b128 v[76:79], v112 offset:6144
  ds_read_b64_tr_b16 v[12:13], v115 offset:32
  ds_read_b64_tr_b16 v[14:15], v115 offset:3616
  ds_read_b64_tr_b16 v[16:17], v114 offset:64
  ds_read_b64_tr_b16 v[18:19], v114 offset:3648
  ds_read_b64_tr_b16 v[20:21], v115 offset:160
  ds_read_b64_tr_b16 v[22:23], v115 offset:3744
  ds_read_b64_tr_b16 v[24:25], v114 offset:192
  ds_read_b64_tr_b16 v[26:27], v114 offset:3776
  ds_read_b64_tr_b16 v[28:29], v114 offset:320
  ds_read_b64_tr_b16 v[30:31], v114 offset:3904
  ds_read_b64_tr_b16 v[32:33], v115 offset:352
  ds_read_b64_tr_b16 v[34:35], v115 offset:3936
  s_waitcnt lgkmcnt(0)
L_s1_loop_A0:
  v_mfma_f32_16x16x32_bf16 v[128:131], v[64:67], v[8:11], v[128:131]
  ds_read_b64_tr_b16 v[36:37], v114 offset:14336
  v_mfma_f32_16x16x32_bf16 v[132:135], v[68:71], v[8:11], v[132:135]
  ds_read_b64_tr_b16 v[38:39], v114 offset:17920
  v_mfma_f32_16x16x32_bf16 v[136:139], v[72:75], v[8:11], v[136:139]
  ds_read_b128 v[80:83], v113 offset:0
  v_mfma_f32_16x16x32_bf16 v[140:143], v[76:79], v[8:11], v[140:143]
  ds_read_b128 v[84:87], v113 offset:2048
  v_mfma_f32_16x16x32_bf16 v[144:147], v[64:67], v[12:15], v[144:147]
  ds_read_b128 v[88:91], v113 offset:4096
  v_mfma_f32_16x16x32_bf16 v[148:151], v[68:71], v[12:15], v[148:151]
  ds_read_b128 v[92:95], v113 offset:6144
  v_mfma_f32_16x16x32_bf16 v[152:155], v[72:75], v[12:15], v[152:155]
  ds_read_b64_tr_b16 v[40:41], v115 offset:14368
  v_mfma_f32_16x16x32_bf16 v[156:159], v[76:79], v[12:15], v[156:159]
  ds_read_b64_tr_b16 v[42:43], v115 offset:17952
  v_mfma_f32_16x16x32_bf16 v[160:163], v[64:67], v[16:19], v[160:163]
  ds_read_b64_tr_b16 v[44:45], v114 offset:14400
  v_mfma_f32_16x16x32_bf16 v[164:167], v[68:71], v[16:19], v[164:167]
  ds_read_b64_tr_b16 v[46:47], v114 offset:17984
  v_mfma_f32_16x16x32_bf16 v[168:171], v[72:75], v[16:19], v[168:171]
  ds_read_b64_tr_b16 v[48:49], v115 offset:14496
  v_mfma_f32_16x16x32_bf16 v[172:175], v[76:79], v[16:19], v[172:175]
  ds_read_b64_tr_b16 v[50:51], v115 offset:18080
  v_mfma_f32_16x16x32_bf16 v[176:179], v[64:67], v[20:23], v[176:179]
  ds_read_b64_tr_b16 v[52:53], v114 offset:14528
  v_mfma_f32_16x16x32_bf16 v[180:183], v[68:71], v[20:23], v[180:183]
  ds_read_b64_tr_b16 v[54:55], v114 offset:18112
  v_mfma_f32_16x16x32_bf16 v[184:187], v[72:75], v[20:23], v[184:187]
  ds_read_b64_tr_b16 v[56:57], v114 offset:14656
  v_mfma_f32_16x16x32_bf16 v[188:191], v[76:79], v[20:23], v[188:191]
  ds_read_b64_tr_b16 v[58:59], v114 offset:18240
  v_mfma_f32_16x16x32_bf16 v[192:195], v[64:67], v[24:27], v[192:195]
  ds_read_b64_tr_b16 v[60:61], v115 offset:14688
  v_mfma_f32_16x16x32_bf16 v[196:199], v[68:71], v[24:27], v[196:199]
  ds_read_b64_tr_b16 v[62:63], v115 offset:18272
  v_mfma_f32_16x16x32_bf16 v[200:203], v[72:75], v[24:27], v[200:203]
  v_mfma_f32_16x16x32_bf16 v[204:207], v[76:79], v[24:27], v[204:207]
  v_mfma_f32_16x16x32_bf16 v[208:211], v[28:31], v[64:67], v[208:211]
  v_mfma_f32_16x16x32_bf16 v[212:215], v[28:31], v[68:71], v[212:215]
  v_mfma_f32_16x16x32_bf16 v[216:219], v[28:31], v[72:75], v[216:219]
  v_mfma_f32_16x16x32_bf16 v[220:223], v[28:31], v[76:79], v[220:223]
  v_mfma_f32_16x16x32_bf16 v[224:227], v[32:35], v[64:67], v[224:227]
  v_mfma_f32_16x16x32_bf16 v[228:231], v[32:35], v[68:71], v[228:231]
  v_mfma_f32_16x16x32_bf16 v[232:235], v[32:35], v[72:75], v[232:235]
  v_mfma_f32_16x16x32_bf16 v[236:239], v[32:35], v[76:79], v[236:239]
  s_add_u32 s58, s58, 45056
  s_cmp_eq_u32 s58, 135168
  s_cselect_b32 s58, 0, s58
  s_waitcnt lgkmcnt(0)
  s_barrier
  v_mfma_f32_16x16x32_bf16 v[128:131], v[80:83], v[36:39], v[128:131]
  v_add_u32 v112, s58, v105
  v_mfma_f32_16x16x32_bf16 v[132:135], v[84:87], v[36:39], v[132:135]
  v_add_u32 v113, s58, v106
  v_mfma_f32_16x16x32_bf16 v[136:139], v[88:91], v[36:39], v[136:139]
  v_add_u32 v114, s58, v107
  v_mfma_f32_16x16x32_bf16 v[140:143], v[92:95], v[36:39], v[140:143]
  v_add_u32 v115, s58, v108
  v_mfma_f32_16x16x32_bf16 v[144:147], v[80:83], v[40:43], v[144:147]
  ds_read_b64_tr_b16 v[8:9], v114 offset:0
  v_mfma_f32_16x16x32_bf16 v[148:151], v[84:87], v[40:43], v[148:151]
  ds_read_b64_tr_b16 v[10:11], v114 offset:3584
  v_mfma_f32_16x16x32_bf16 v[152:155], v[88:91], v[40:43], v[152:155]
  ds_read_b128 v[64:67], v112 offset:0
  v_mfma_f32_16x16x32_bf16 v[156:159], v[92:95], v[40:43], v[156:159]
  ds_read_b128 v[68:71], v112 offset:2048
  v_mfma_f32_16x16x32_bf16 v[160:163], v[80:83], v[44:47], v[160:163]
  ds_read_b128 v[72:75], v112 offset:4096
  v_mfma_f32_16x16x32_bf16 v[164:167], v[84:87], v[44:47], v[164:167]
  ds_read_b128 v[76:79], v112 offset:6144
  v_mfma_f32_16x16x32_bf16 v[168:171], v[88:91], v[44:47], v[168:171]
  ds_read_b64_tr_b16 v[12:13], v115 offset:32
  v_mfma_f32_16x16x32_bf16 v[172:175], v[92:95], v[44:47], v[172:175]
  ds_read_b64_tr_b16 v[14:15], v115 offset:3616
  v_mfma_f32_16x16x32_bf16 v[176:179], v[80:83], v[48:51], v[176:179]
  ds_read_b64_tr_b16 v[16:17], v114 offset:64
  v_mfma_f32_16x16x32_bf16 v[180:183], v[84:87], v[48:51], v[180:183]
  ds_read_b64_tr_b16 v[18:19], v114 offset:3648
  v_mfma_f32_16x16x32_bf16 v[184:187], v[88:91], v[48:51], v[184:187]
  ds_read_b64_tr_b16 v[20:21], v115 offset:160
  v_mfma_f32_16x16x32_bf16 v[188:191], v[92:95], v[48:51], v[188:191]
  ds_read_b64_tr_b16 v[22:23], v115 offset:3744
  v_mfma_f32_16x16x32_bf16 v[192:195], v[80:83], v[52:55], v[192:195]
  ds_read_b64_tr_b16 v[24:25], v114 offset:192
  v_mfma_f32_16x16x32_bf16 v[196:199], v[84:87], v[52:55], v[196:199]
  ds_read_b64_tr_b16 v[26:27], v114 offset:3776
  v_mfma_f32_16x16x32_bf16 v[200:203], v[88:91], v[52:55], v[200:203]
  ds_read_b64_tr_b16 v[28:29], v114 offset:320
  v_mfma_f32_16x16x32_bf16 v[204:207], v[92:95], v[52:55], v[204:207]
  ds_read_b64_tr_b16 v[30:31], v114 offset:3904
  v_mfma_f32_16x16x32_bf16 v[208:211], v[56:59], v[80:83], v[208:211]
  ds_read_b64_tr_b16 v[32:33], v115 offset:352
  v_mfma_f32_16x16x32_bf16 v[212:215], v[56:59], v[84:87], v[212:215]
  ds_read_b64_tr_b16 v[34:35], v115 offset:3936
  v_mfma_f32_16x16x32_bf16 v[216:219], v[56:59], v[88:91], v[216:219]
  v_mfma_f32_16x16x32_bf16 v[220:223], v[56:59], v[92:95], v[220:223]
  v_mfma_f32_16x16x32_bf16 v[224:227], v[60:63], v[80:83], v[224:227]
  v_mfma_f32_16x16x32_bf16 v[228:231], v[60:63], v[84:87], v[228:231]
  v_mfma_f32_16x16x32_bf16 v[232:235], v[60:63], v[88:91], v[232:235]
  v_mfma_f32_16x16x32_bf16 v[236:239], v[60:63], v[92:95], v[236:239]
  s_add_u32 s59, s59, 1
  s_cmp_lt_u32 s59, 10
  s_waitcnt lgkmcnt(0)
  s_cbranch_scc1 L_s1_loop_A0
  v_and_b32 v2, 15, v1
  v_lshrrev_b32 v3, 4, v1
  s_lshl_b32 s60, s32, 7
  s_lshl_b32 s63, s52, 6
  s_add_u32 s60, s60, s63
  v_mul_u32_u24 v5, 272, v2
  v_lshlrev_b32 v6, 3, v3
  s_lshl_b32 s63, s52, 7
  v_add3_u32 v5, v5, v6, s63
  v_pk_mul_f32 v[96:97], v[128:129], s[78:79]
  v_pk_mul_f32 v[98:99], v[130:131], s[78:79]
  v_pk_mul_f32 v[100:101], v[132:133], s[78:79]
  v_pk_mul_f32 v[102:103], v[134:135], s[78:79]
  v_pk_mul_f32 v[104:105], v[136:137], s[78:79]
  v_pk_mul_f32 v[106:107], v[138:139], s[78:79]
  v_pk_mul_f32 v[108:109], v[140:141], s[78:79]
  v_pk_mul_f32 v[110:111], v[142:143], s[78:79]
  v_exp_f32_e64 v96, v96 clamp
  v_max_f32 v128, s80, v128
  v_exp_f32_e64 v97, v97 clamp
  v_max_f32 v129, s80, v129
  v_exp_f32_e64 v98, v98 clamp
  v_max_f32 v130, s80, v130
  v_exp_f32_e64 v99, v99 clamp
  v_max_f32 v131, s80, v131
  v_exp_f32_e64 v100, v100 clamp
  v_max_f32 v132, s80, v132
  v_exp_f32_e64 v101, v101 clamp
  v_max_f32 v133, s80, v133
  v_exp_f32_e64 v102, v102 clamp
  v_max_f32 v134, s80, v134
  v_exp_f32_e64 v103, v103 clamp
  v_max_f32 v135, s80, v135
  v_exp_f32_e64 v104, v104 clamp
  v_max_f32 v136, s80, v136
  v_exp_f32_e64 v105, v105 clamp
  v_max_f32 v137, s80, v137
  v_exp_f32_e64 v106, v106 clamp
  v_max_f32 v138, s80, v138
  v_exp_f32_e64 v107, v107 clamp
  v_max_f32 v139, s80, v139
  v_exp_f32_e64 v108, v108 clamp
  v_max_f32 v140, s80, v140
  v_exp_f32_e64 v109, v109 clamp
  v_max_f32 v141, s80, v141
  v_exp_f32_e64 v110, v110 clamp
  v_max_f32 v142, s80, v142
  v_exp_f32_e64 v111, v111 clamp
  v_max_f32 v143, s80, v143
  v_pk_add_f32 v[128:129], v[128:129], v[96:97]
  v_pk_add_f32 v[130:131], v[130:131], v[98:99]
  v_pk_add_f32 v[132:133], v[132:133], v[100:101]
  v_pk_add_f32 v[134:135], v[134:135], v[102:103]
  v_pk_add_f32 v[136:137], v[136:137], v[104:105]
  v_pk_add_f32 v[138:139], v[138:139], v[106:107]
  v_pk_add_f32 v[140:141], v[140:141], v[108:109]
  v_pk_add_f32 v[142:143], v[142:143], v[110:111]
  v_cvt_pk_bf16_f32 v128, v128, v129
  v_cvt_pk_bf16_f32 v129, v130, v131
  ds_write_b64 v5, v[128:129] offset:0
  v_cvt_pk_bf16_f32 v132, v132, v133
  v_cvt_pk_bf16_f32 v133, v134, v135
  ds_write_b64 v5, v[132:133] offset:32
  v_cvt_pk_bf16_f32 v136, v136, v137
  v_cvt_pk_bf16_f32 v137, v138, v139
  ds_write_b64 v5, v[136:137] offset:64
  v_cvt_pk_bf16_f32 v140, v140, v141
  v_cvt_pk_bf16_f32 v141, v142, v143
  ds_write_b64 v5, v[140:141] offset:96
  v_pk_mul_f32 v[96:97], v[144:145], s[78:79]
  v_pk_mul_f32 v[98:99], v[146:147], s[78:79]
  v_pk_mul_f32 v[100:101], v[148:149], s[78:79]
  v_pk_mul_f32 v[102:103], v[150:151], s[78:79]
  v_pk_mul_f32 v[104:105], v[152:153], s[78:79]
  v_pk_mul_f32 v[106:107], v[154:155], s[78:79]
  v_pk_mul_f32 v[108:109], v[156:157], s[78:79]
  v_pk_mul_f32 v[110:111], v[158:159], s[78:79]
  v_exp_f32_e64 v96, v96 clamp
  v_max_f32 v144, s80, v144
  v_exp_f32_e64 v97, v97 clamp
  v_max_f32 v145, s80, v145
  v_exp_f32_e64 v98, v98 clamp
  v_max_f32 v146, s80, v146
  v_exp_f32_e64 v99, v99 clamp
  v_max_f32 v147, s80, v147
  v_exp_f32_e64 v100, v100 clamp
  v_max_f32 v148, s80, v148
  v_exp_f32_e64 v101, v101 clamp
  v_max_f32 v149, s80, v149
  v_exp_f32_e64 v102, v102 clamp
  v_max_f32 v150, s80, v150
  v_exp_f32_e64 v103, v103 clamp
  v_max_f32 v151, s80, v151
  v_exp_f32_e64 v104, v104 clamp
  v_max_f32 v152, s80, v152
  v_exp_f32_e64 v105, v105 clamp
  v_max_f32 v153, s80, v153
  v_exp_f32_e64 v106, v106 clamp
  v_max_f32 v154, s80, v154
  v_exp_f32_e64 v107, v107 clamp
  v_max_f32 v155, s80, v155
  v_exp_f32_e64 v108, v108 clamp
  v_max_f32 v156, s80, v156
  v_exp_f32_e64 v109, v109 clamp
  v_max_f32 v157, s80, v157
  v_exp_f32_e64 v110, v110 clamp
  v_max_f32 v158, s80, v158
  v_exp_f32_e64 v111, v111 clamp
  v_max_f32 v159, s80, v159
  v_pk_add_f32 v[144:145], v[144:145], v[96:97]
  v_pk_add_f32 v[146:147], v[146:147], v[98:99]
  v_pk_add_f32 v[148:149], v[148:149], v[100:101]
  v_pk_add_f32 v[150:151], v[150:151], v[102:103]
  v_pk_add_f32 v[152:153], v[152:153], v[104:105]
  v_pk_add_f32 v[154:155], v[154:155], v[106:107]
  v_pk_add_f32 v[156:157], v[156:157], v[108:109]
  v_pk_add_f32 v[158:159], v[158:159], v[110:111]
  v_cvt_pk_bf16_f32 v144, v144, v145
  v_cvt_pk_bf16_f32 v145, v146, v147
  ds_write_b64 v5, v[144:145] offset:4352
  v_cvt_pk_bf16_f32 v148, v148, v149
  v_cvt_pk_bf16_f32 v149, v150, v151
  ds_write_b64 v5, v[148:149] offset:4384
  v_cvt_pk_bf16_f32 v152, v152, v153
  v_cvt_pk_bf16_f32 v153, v154, v155
  ds_write_b64 v5, v[152:153] offset:4416
  v_cvt_pk_bf16_f32 v156, v156, v157
  v_cvt_pk_bf16_f32 v157, v158, v159
  ds_write_b64 v5, v[156:157] offset:4448
  v_pk_mul_f32 v[96:97], v[160:161], s[78:79]
  v_pk_mul_f32 v[98:99], v[162:163], s[78:79]
  v_pk_mul_f32 v[100:101], v[164:165], s[78:79]
  v_pk_mul_f32 v[102:103], v[166:167], s[78:79]
  v_pk_mul_f32 v[104:105], v[168:169], s[78:79]
  v_pk_mul_f32 v[106:107], v[170:171], s[78:79]
  v_pk_mul_f32 v[108:109], v[172:173], s[78:79]
  v_pk_mul_f32 v[110:111], v[174:175], s[78:79]
  v_exp_f32_e64 v96, v96 clamp
  v_max_f32 v160, s80, v160
  v_exp_f32_e64 v97, v97 clamp
  v_max_f32 v161, s80, v161
  v_exp_f32_e64 v98, v98 clamp
  v_max_f32 v162, s80, v162
  v_exp_f32_e64 v99, v99 clamp
  v_max_f32 v163, s80, v163
  v_exp_f32_e64 v100, v100 clamp
  v_max_f32 v164, s80, v164
  v_exp_f32_e64 v101, v101 clamp
  v_max_f32 v165, s80, v165
  v_exp_f32_e64 v102, v102 clamp
  v_max_f32 v166, s80, v166
  v_exp_f32_e64 v103, v103 clamp
  v_max_f32 v167, s80, v167
  v_exp_f32_e64 v104, v104 clamp
  v_max_f32 v168, s80, v168
  v_exp_f32_e64 v105, v105 clamp
  v_max_f32 v169, s80, v169
  v_exp_f32_e64 v106, v106 clamp
  v_max_f32 v170, s80, v170
  v_exp_f32_e64 v107, v107 clamp
  v_max_f32 v171, s80, v171
  v_exp_f32_e64 v108, v108 clamp
  v_max_f32 v172, s80, v172
  v_exp_f32_e64 v109, v109 clamp
  v_max_f32 v173, s80, v173
  v_exp_f32_e64 v110, v110 clamp
  v_max_f32 v174, s80, v174
  v_exp_f32_e64 v111, v111 clamp
  v_max_f32 v175, s80, v175
  v_pk_add_f32 v[160:161], v[160:161], v[96:97]
  v_pk_add_f32 v[162:163], v[162:163], v[98:99]
  v_pk_add_f32 v[164:165], v[164:165], v[100:101]
  v_pk_add_f32 v[166:167], v[166:167], v[102:103]
  v_pk_add_f32 v[168:169], v[168:169], v[104:105]
  v_pk_add_f32 v[170:171], v[170:171], v[106:107]
  v_pk_add_f32 v[172:173], v[172:173], v[108:109]
  v_pk_add_f32 v[174:175], v[174:175], v[110:111]
  v_cvt_pk_bf16_f32 v160, v160, v161
  v_cvt_pk_bf16_f32 v161, v162, v163
  ds_write_b64 v5, v[160:161] offset:8704
  v_cvt_pk_bf16_f32 v164, v164, v165
  v_cvt_pk_bf16_f32 v165, v166, v167
  ds_write_b64 v5, v[164:165] offset:8736
  v_cvt_pk_bf16_f32 v168, v168, v169
  v_cvt_pk_bf16_f32 v169, v170, v171
  ds_write_b64 v5, v[168:169] offset:8768
  v_cvt_pk_bf16_f32 v172, v172, v173
  v_cvt_pk_bf16_f32 v173, v174, v175
  ds_write_b64 v5, v[172:173] offset:8800
  v_cvt_pk_bf16_f32 v176, v176, v177
  v_cvt_pk_bf16_f32 v177, v178, v179
  ds_write_b64 v5, v[176:177] offset:21760
  v_cvt_pk_bf16_f32 v180, v180, v181
  v_cvt_pk_bf16_f32 v181, v182, v183
  ds_write_b64 v5, v[180:181] offset:21792
  v_cvt_pk_bf16_f32 v184, v184, v185
  v_cvt_pk_bf16_f32 v185, v186, v187
  ds_write_b64 v5, v[184:185] offset:21824
  v_cvt_pk_bf16_f32 v188, v188, v189
  v_cvt_pk_bf16_f32 v189, v190, v191
  ds_write_b64 v5, v[188:189] offset:21856
  v_cvt_pk_bf16_f32 v192, v192, v193
  v_cvt_pk_bf16_f32 v193, v194, v195
  ds_write_b64 v5, v[192:193] offset:26112
  v_cvt_pk_bf16_f32 v196, v196, v197
  v_cvt_pk_bf16_f32 v197, v198, v199
  ds_write_b64 v5, v[196:197] offset:26144
  v_cvt_pk_bf16_f32 v200, v200, v201
  v_cvt_pk_bf16_f32 v201, v202, v203
  ds_write_b64 v5, v[200:201] offset:26176
  v_cvt_pk_bf16_f32 v204, v204, v205
  v_cvt_pk_bf16_f32 v205, v206, v207
  ds_write_b64 v5, v[204:205] offset:26208
  s_lshl_b32 s63, s33, 4
  s_add_u32 s63, s63, 0
  s_lshr_b32 s64, s60, 4
  s_mul_i32 s64, s64, 160
  s_add_u32 s63, s63, s64
  s_lshl_b32 s63, s63, 7
  s_add_u32 s63, s63, 0x600000
  v_lshlrev_b32 v7, 3, v1
  v_pk_mul_f32 v[96:97], v[208:209], s[78:79]
  v_pk_mul_f32 v[98:99], v[210:211], s[78:79]
  v_pk_mul_f32 v[100:101], v[212:213], s[78:79]
  v_pk_mul_f32 v[102:103], v[214:215], s[78:79]
  v_pk_mul_f32 v[104:105], v[216:217], s[78:79]
  v_pk_mul_f32 v[106:107], v[218:219], s[78:79]
  v_pk_mul_f32 v[108:109], v[220:221], s[78:79]
  v_pk_mul_f32 v[110:111], v[222:223], s[78:79]
  v_exp_f32_e64 v96, v96 clamp
  v_max_f32 v208, s80, v208
  v_exp_f32_e64 v97, v97 clamp
  v_max_f32 v209, s80, v209
  v_exp_f32_e64 v98, v98 clamp
  v_max_f32 v210, s80, v210
  v_exp_f32_e64 v99, v99 clamp
  v_max_f32 v211, s80, v211
  v_exp_f32_e64 v100, v100 clamp
  v_max_f32 v212, s80, v212
  v_exp_f32_e64 v101, v101 clamp
  v_max_f32 v213, s80, v213
  v_exp_f32_e64 v102, v102 clamp
  v_max_f32 v214, s80, v214
  v_exp_f32_e64 v103, v103 clamp
  v_max_f32 v215, s80, v215
  v_exp_f32_e64 v104, v104 clamp
  v_max_f32 v216, s80, v216
  v_exp_f32_e64 v105, v105 clamp
  v_max_f32 v217, s80, v217
  v_exp_f32_e64 v106, v106 clamp
  v_max_f32 v218, s80, v218
  v_exp_f32_e64 v107, v107 clamp
  v_max_f32 v219, s80, v219
  v_exp_f32_e64 v108, v108 clamp
  v_max_f32 v220, s80, v220
  v_exp_f32_e64 v109, v109 clamp
  v_max_f32 v221, s80, v221
  v_exp_f32_e64 v110, v110 clamp
  v_max_f32 v222, s80, v222
  v_exp_f32_e64 v111, v111 clamp
  v_max_f32 v223, s80, v223
  v_pk_add_f32 v[208:209], v[208:209], v[96:97]
  v_pk_add_f32 v[210:211], v[210:211], v[98:99]
  v_pk_add_f32 v[212:213], v[212:213], v[100:101]
  v_pk_add_f32 v[214:215], v[214:215], v[102:103]
  v_pk_add_f32 v[216:217], v[216:217], v[104:105]
  v_pk_add_f32 v[218:219], v[218:219], v[106:107]
  v_pk_add_f32 v[220:221], v[220:221], v[108:109]
  v_pk_add_f32 v[222:223], v[222:223], v[110:111]
  v_cvt_pk_bf16_f32 v208, v208, v209
  v_cvt_pk_bf16_f32 v209, v210, v211
  s_add_u32 s64, s63, 0
  buffer_store_dwordx2 v[208:209], v7, s[20:23], s64 offen
  v_cvt_pk_bf16_f32 v212, v212, v213
  v_cvt_pk_bf16_f32 v213, v214, v215
  s_add_u32 s64, s63, 20480
  buffer_store_dwordx2 v[212:213], v7, s[20:23], s64 offen
  v_cvt_pk_bf16_f32 v216, v216, v217
  v_cvt_pk_bf16_f32 v217, v218, v219
  s_add_u32 s64, s63, 40960
  buffer_store_dwordx2 v[216:217], v7, s[20:23], s64 offen
  v_cvt_pk_bf16_f32 v220, v220, v221
  v_cvt_pk_bf16_f32 v221, v222, v223
  s_add_u32 s64, s63, 61440
  buffer_store_dwordx2 v[220:221], v7, s[20:23], s64 offen
  s_waitcnt lgkmcnt(0)
  s_barrier
  s_mul_i32 s63, s35, 5440
  v_mul_u32_u24 v5, 272, v2
  v_lshlrev_b32 v6, 4, v3
  v_add3_u32 v5, v5, v6, s63
  ds_read_b128 v[16:19], v5 offset:0
  ds_read_b128 v[20:23], v5 offset:4352
  ds_read_b128 v[24:27], v5 offset:21760
  ds_read_b128 v[28:31], v5 offset:26112
  ds_read_b128 v[32:35], v5 offset:64
  ds_read_b128 v[36:39], v5 offset:4416
  ds_read_b128 v[40:43], v5 offset:21824
  ds_read_b128 v[44:47], v5 offset:26176
  ds_read_b128 v[48:51], v5 offset:128
  ds_read_b128 v[52:55], v5 offset:4480
  ds_read_b128 v[56:59], v5 offset:21888
  ds_read_b128 v[60:63], v5 offset:26240
  ds_read_b128 v[64:67], v5 offset:192
  ds_read_b128 v[68:71], v5 offset:4544
  ds_read_b128 v[72:75], v5 offset:21952
  ds_read_b128 v[76:79], v5 offset:26304
  s_lshl_b32 s63, s33, 4
  s_add_u32 s63, s63, 4
  s_lshr_b32 s64, s60, 4
  s_mul_i32 s64, s64, 160
  s_add_u32 s63, s63, s64
  s_lshl_b32 s63, s63, 7
  s_add_u32 s63, s63, 0x600000
  v_lshlrev_b32 v7, 3, v1
  v_pk_mul_f32 v[96:97], v[224:225], s[78:79]
  v_pk_mul_f32 v[98:99], v[226:227], s[78:79]
  v_pk_mul_f32 v[100:101], v[228:229], s[78:79]
  v_pk_mul_f32 v[102:103], v[230:231], s[78:79]
  v_pk_mul_f32 v[104:105], v[232:233], s[78:79]
  v_pk_mul_f32 v[106:107], v[234:235], s[78:79]
  v_pk_mul_f32 v[108:109], v[236:237], s[78:79]
  v_pk_mul_f32 v[110:111], v[238:239], s[78:79]
  v_exp_f32_e64 v96, v96 clamp
  v_max_f32 v224, s80, v224
  v_exp_f32_e64 v97, v97 clamp
  v_max_f32 v225, s80, v225
  v_exp_f32_e64 v98, v98 clamp
  v_max_f32 v226, s80, v226
  v_exp_f32_e64 v99, v99 clamp
  v_max_f32 v227, s80, v227
  v_exp_f32_e64 v100, v100 clamp
  v_max_f32 v228, s80, v228
  v_exp_f32_e64 v101, v101 clamp
  v_max_f32 v229, s80, v229
  v_exp_f32_e64 v102, v102 clamp
  v_max_f32 v230, s80, v230
  v_exp_f32_e64 v103, v103 clamp
  v_max_f32 v231, s80, v231
  v_exp_f32_e64 v104, v104 clamp
  v_max_f32 v232, s80, v232
  v_exp_f32_e64 v105, v105 clamp
  v_max_f32 v233, s80, v233
  v_exp_f32_e64 v106, v106 clamp
  v_max_f32 v234, s80, v234
  v_exp_f32_e64 v107, v107 clamp
  v_max_f32 v235, s80, v235
  v_exp_f32_e64 v108, v108 clamp
  v_max_f32 v236, s80, v236
  v_exp_f32_e64 v109, v109 clamp
  v_max_f32 v237, s80, v237
  v_exp_f32_e64 v110, v110 clamp
  v_max_f32 v238, s80, v238
  v_exp_f32_e64 v111, v111 clamp
  v_max_f32 v239, s80, v239
  v_pk_add_f32 v[224:225], v[224:225], v[96:97]
  v_pk_add_f32 v[226:227], v[226:227], v[98:99]
  v_pk_add_f32 v[228:229], v[228:229], v[100:101]
  v_pk_add_f32 v[230:231], v[230:231], v[102:103]
  v_pk_add_f32 v[232:233], v[232:233], v[104:105]
  v_pk_add_f32 v[234:235], v[234:235], v[106:107]
  v_pk_add_f32 v[236:237], v[236:237], v[108:109]
  v_pk_add_f32 v[238:239], v[238:239], v[110:111]
  v_cvt_pk_bf16_f32 v224, v224, v225
  v_cvt_pk_bf16_f32 v225, v226, v227
  s_add_u32 s64, s63, 0
  buffer_store_dwordx2 v[224:225], v7, s[20:23], s64 offen
  v_cvt_pk_bf16_f32 v228, v228, v229
  v_cvt_pk_bf16_f32 v229, v230, v231
  s_add_u32 s64, s63, 20480
  buffer_store_dwordx2 v[228:229], v7, s[20:23], s64 offen
  v_cvt_pk_bf16_f32 v232, v232, v233
  v_cvt_pk_bf16_f32 v233, v234, v235
  s_add_u32 s64, s63, 40960
  buffer_store_dwordx2 v[232:233], v7, s[20:23], s64 offen
  v_cvt_pk_bf16_f32 v236, v236, v237
  v_cvt_pk_bf16_f32 v237, v238, v239
  s_add_u32 s64, s63, 61440
  buffer_store_dwordx2 v[236:237], v7, s[20:23], s64 offen
  v_cmp_eq_u32 vcc, 4, v2
  v_mov_b32 v6, 0x3f803f80
  s_waitcnt lgkmcnt(0)
  v_cndmask_b32 v28, v28, v6, vcc
  v_cndmask_b32 v29, v29, v6, vcc
  v_cndmask_b32 v30, v30, v6, vcc
  v_cndmask_b32 v31, v31, v6, vcc
  v_cndmask_b32 v44, v44, v6, vcc
  v_cndmask_b32 v45, v45, v6, vcc
  v_cndmask_b32 v46, v46, v6, vcc
  v_cndmask_b32 v47, v47, v6, vcc
  v_cndmask_b32 v60, v60, v6, vcc
  v_cndmask_b32 v61, v61, v6, vcc
  v_cndmask_b32 v62, v62, v6, vcc
  v_cndmask_b32 v63, v63, v6, vcc
  v_cndmask_b32 v76, v76, v6, vcc
  v_cndmask_b32 v77, v77, v6, vcc
  v_cndmask_b32 v78, v78, v6, vcc
  v_cndmask_b32 v79, v79, v6, vcc
  s_nop 1
  v_mfma_f32_16x16x32_bf16 v[80:83], v[16:19], v[24:27], 0
  v_mfma_f32_16x16x32_bf16 v[84:87], v[16:19], v[28:31], 0
  v_mfma_f32_16x16x32_bf16 v[88:91], v[20:23], v[24:27], 0
  v_mfma_f32_16x16x32_bf16 v[92:95], v[20:23], v[28:31], 0
  v_mfma_f32_16x16x32_bf16 v[80:83], v[32:35], v[40:43], v[80:83]
  v_mfma_f32_16x16x32_bf16 v[84:87], v[32:35], v[44:47], v[84:87]
  v_mfma_f32_16x16x32_bf16 v[88:91], v[36:39], v[40:43], v[88:91]
  v_mfma_f32_16x16x32_bf16 v[92:95], v[36:39], v[44:47], v[92:95]
  v_mfma_f32_16x16x32_bf16 v[80:83], v[48:51], v[56:59], v[80:83]
  v_mfma_f32_16x16x32_bf16 v[84:87], v[48:51], v[60:63], v[84:87]
  v_mfma_f32_16x16x32_bf16 v[88:91], v[52:55], v[56:59], v[88:91]
  v_mfma_f32_16x16x32_bf16 v[92:95], v[52:55], v[60:63], v[92:95]
  v_mfma_f32_16x16x32_bf16 v[80:83], v[64:67], v[72:75], v[80:83]
  v_mfma_f32_16x16x32_bf16 v[84:87], v[64:67], v[76:79], v[84:87]
  v_mfma_f32_16x16x32_bf16 v[88:91], v[68:71], v[72:75], v[88:91]
  v_mfma_f32_16x16x32_bf16 v[92:95], v[68:71], v[76:79], v[92:95]
  s_lshl_b32 s63, s32, 5
  s_lshl_b32 s64, s33, 2
  s_add_u32 s63, s63, s64
  s_add_u32 s63, s63, s35
  s_mul_i32 s63, s63, 1680
  s_add_u32 s63, s63, 0x900000
  v_mul_u32_u24 v5, 80, v2
  v_lshlrev_b32 v6, 4, v3
  v_add_u32 v5, v5, v6
  v_cmp_eq_u32 s[74:75], 0, v3
  v_cmp_gt_u32 s[76:77], 5, v2
  s_nop 7
  buffer_store_dwordx4 v[80:83], v5, s[20:23], s63 offen
  s_and_saveexec_b64 s[72:73], s[74:75]
  buffer_store_dwordx4 v[88:91], v5, s[20:23], s63 offen offset:64
  s_mov_b64 exec, s[76:77]
  buffer_store_dwordx4 v[84:87], v5, s[20:23], s63 offen offset:1280
  s_and_b64 exec, exec, s[74:75]
  buffer_store_dwordx4 v[92:95], v5, s[20:23], s63 offen offset:1344
  s_mov_b64 exec, s[72:73]
  s_endpgm
L_s1_A1:
  v_pk_mov_b32 v[128:129], s[80:81], s[80:81] op_sel:[0,1]
  v_pk_mov_b32 v[130:131], s[80:81], s[80:81] op_sel:[0,1]
  v_pk_mov_b32 v[132:133], s[80:81], s[80:81] op_sel:[0,1]
  v_pk_mov_b32 v[134:135], s[80:81], s[80:81] op_sel:[0,1]
  v_pk_mov_b32 v[136:137], s[80:81], s[80:81] op_sel:[0,1]
  v_pk_mov_b32 v[138:139], s[80:81], s[80:81] op_sel:[0,1]
  v_pk_mov_b32 v[140:141], s[80:81], s[80:81] op_sel:[0,1]
  v_pk_mov_b32 v[142:143], s[80:81], s[80:81] op_sel:[0,1]
  v_pk_mov_b32 v[144:145], s[80:81], s[80:81] op_sel:[0,1]
  v_pk_mov_b32 v[146:147], s[80:81], s[80:81] op_sel:[0,1]
  v_pk_mov_b32 v[148:149], s[80:81], s[80:81] op_sel:[0,1]
  v_pk_mov_b32 v[150:151], s[80:81], s[80:81] op_sel:[0,1]
  v_pk_mov_b32 v[152:153], s[80:81], s[80:81] op_sel:[0,1]
  v_pk_mov_b32 v[154:155], s[80:81], s[80:81] op_sel:[0,1]
  v_pk_mov_b32 v[156:157], s[80:81], s[80:81] op_sel:[0,1]
  v_pk_mov_b32 v[158:159], s[80:81], s[80:81] op_sel:[0,1]
  v_pk_mov_b32 v[160:161], 0, 0
  v_pk_mov_b32 v[162:163], 0, 0
  v_pk_mov_b32 v[164:165], 0, 0
  v_pk_mov_b32 v[166:167], 0, 0
  v_pk_mov_b32 v[168:169], 0, 0
  v_pk_mov_b32 v[170:171], 0, 0
  v_pk_mov_b32 v[172:173], 0, 0
  v_pk_mov_b32 v[174:175], 0, 0
  v_pk_mov_b32 v[176:177], 0, 0
  v_pk_mov_b32 v[178:179], 0, 0
  v_pk_mov_b32 v[180:181], 0, 0
  v_pk_mov_b32 v[182:183], 0, 0
  v_pk_mov_b32 v[184:185], 0, 0
  v_pk_mov_b32 v[186:187], 0, 0
  v_pk_mov_b32 v[188:189], 0, 0
  v_pk_mov_b32 v[190:191], 0, 0
  v_pk_mov_b32 v[192:193], 0, 0
  v_pk_mov_b32 v[194:195], 0, 0
  v_pk_mov_b32 v[196:197], 0, 0
  v_pk_mov_b32 v[198:199], 0, 0
  v_pk_mov_b32 v[200:201], 0, 0
  v_pk_mov_b32 v[202:203], 0, 0
  v_pk_mov_b32 v[204:205], 0, 0
  v_pk_mov_b32 v[206:207], 0, 0
  v_pk_mov_b32 v[208:209], s[80:81], s[80:81] op_sel:[0,1]
  v_pk_mov_b32 v[210:211], s[80:81], s[80:81] op_sel:[0,1]
  v_pk_mov_b32 v[212:213], s[80:81], s[80:81] op_sel:[0,1]
  v_pk_mov_b32 v[214:215], s[80:81], s[80:81] op_sel:[0,1]
  v_pk_mov_b32 v[216:217], s[80:81], s[80:81] op_sel:[0,1]
  v_pk_mov_b32 v[218:219], s[80:81], s[80:81] op_sel:[0,1]
  v_pk_mov_b32 v[220:221], s[80:81], s[80:81] op_sel:[0,1]
  v_pk_mov_b32 v[222:223], s[80:81], s[80:81] op_sel:[0,1]
  v_pk_mov_b32 v[224:225], s[80:81], s[80:81] op_sel:[0,1]
  v_pk_mov_b32 v[226:227], s[80:81], s[80:81] op_sel:[0,1]
  v_pk_mov_b32 v[228:229], s[80:81], s[80:81] op_sel:[0,1]
  v_pk_mov_b32 v[230:231], s[80:81], s[80:81] op_sel:[0,1]
  v_pk_mov_b32 v[232:233], s[80:81], s[80:81] op_sel:[0,1]
  v_pk_mov_b32 v[234:235], s[80:81], s[80:81] op_sel:[0,1]
  v_pk_mov_b32 v[236:237], s[80:81], s[80:81] op_sel:[0,1]
  v_pk_mov_b32 v[238:239], s[80:81], s[80:81] op_sel:[0,1]
  v_add_u32 v112, s58, v105
  v_add_u32 v113, s58, v106
  v_add_u32 v114, s58, v107
  v_add_u32 v115, s58, v108
  s_barrier
  ds_read_b64_tr_b16 v[8:9], v115 offset:96
  ds_read_b64_tr_b16 v[10:11], v115 offset:3680
  ds_read_b128 v[64:67], v112 offset:0
  ds_read_b128 v[68:71], v112 offset:2048
  ds_read_b128 v[72:75], v112 offset:4096
  ds_read_b128 v[76:79], v112 offset:6144
  ds_read_b64_tr_b16 v[12:13], v114 offset:128
  ds_read_b64_tr_b16 v[14:15], v114 offset:3712
  ds_read_b64_tr_b16 v[16:17], v115 offset:224
  ds_read_b64_tr_b16 v[18:19], v115 offset:3808
  ds_read_b64_tr_b16 v[20:21], v114 offset:256
  ds_read_b64_tr_b16 v[22:23], v114 offset:3840
  ds_read_b64_tr_b16 v[24:25], v115 offset:288
  ds_read_b64_tr_b16 v[26:27], v115 offset:3872
  ds_read_b64_tr_b16 v[28:29], v114 offset:384
  ds_read_b64_tr_b16 v[30:31], v114 offset:3968
  ds_read_b64_tr_b16 v[32:33], v115 offset:416
  ds_read_b64_tr_b16 v[34:35], v115 offset:4000
  s_waitcnt lgkmcnt(0)
L_s1_loop_A1:
  v_mfma_f32_16x16x32_bf16 v[128:131], v[64:67], v[8:11], v[128:131]
  ds_read_b64_tr_b16 v[36:37], v115 offset:14432
  v_mfma_f32_16x16x32_bf16 v[132:135], v[68:71], v[8:11], v[132:135]
  ds_read_b64_tr_b16 v[38:39], v115 offset:18016
  v_mfma_f32_16x16x32_bf16 v[136:139], v[72:75], v[8:11], v[136:139]
  ds_read_b128 v[80:83], v113 offset:0
  v_mfma_f32_16x16x32_bf16 v[140:143], v[76:79], v[8:11], v[140:143]
  ds_read_b128 v[84:87], v113 offset:2048
  v_mfma_f32_16x16x32_bf16 v[144:147], v[64:67], v[12:15], v[144:147]
  ds_read_b128 v[88:91], v113 offset:4096
  v_mfma_f32_16x16x32_bf16 v[148:151], v[68:71], v[12:15], v[148:151]
  ds_read_b128 v[92:95], v113 offset:6144
  v_mfma_f32_16x16x32_bf16 v[152:155], v[72:75], v[12:15], v[152:155]
  ds_read_b64_tr_b16 v[40:41], v114 offset:14464
  v_mfma_f32_16x16x32_bf16 v[156:159], v[76:79], v[12:15], v[156:159]
  ds_read_b64_tr_b16 v[42:43], v114 offset:18048
  v_mfma_f32_16x16x32_bf16 v[160:163], v[64:67], v[16:19], v[160:163]
  ds_read_b64_tr_b16 v[44:45], v115 offset:14560
  v_mfma_f32_16x16x32_bf16 v[164:167], v[68:71], v[16:19], v[164:167]
  ds_read_b64_tr_b16 v[46:47], v115 offset:18144
  v_mfma_f32_16x16x32_bf16 v[168:171], v[72:75], v[16:19], v[168:171]
  ds_read_b64_tr_b16 v[48:49], v114 offset:14592
  v_mfma_f32_16x16x32_bf16 v[172:175], v[76:79], v[16:19], v[172:175]
  ds_read_b64_tr_b16 v[50:51], v114 offset:18176
  v_mfma_f32_16x16x32_bf16 v[176:179], v[64:67], v[20:23], v[176:179]
  ds_read_b64_tr_b16 v[52:53], v115 offset:14624
  v_mfma_f32_16x16x32_bf16 v[180:183], v[68:71], v[20:23], v[180:183]
  ds_read_b64_tr_b16 v[54:55], v115 offset:18208
  v_mfma_f32_16x16x32_bf16 v[184:187], v[72:75], v[20:23], v[184:187]
  ds_read_b64_tr_b16 v[56:57], v114 offset:14720
  v_mfma_f32_16x16x32_bf16 v[188:191], v[76:79], v[20:23], v[188:191]
  ds_read_b64_tr_b16 v[58:59], v114 offset:18304
  v_mfma_f32_16x16x32_bf16 v[192:195], v[64:67], v[24:27], v[192:195]
  ds_read_b64_tr_b16 v[60:61], v115 offset:14752
  v_mfma_f32_16x16x32_bf16 v[196:199], v[68:71], v[24:27], v[196:199]
  ds_read_b64_tr_b16 v[62:63], v115 offset:18336
  v_mfma_f32_16x16x32_bf16 v[200:203], v[72:75], v[24:27], v[200:203]
  v_mfma_f32_16x16x32_bf16 v[204:207], v[76:79], v[24:27], v[204:207]
  v_mfma_f32_16x16x32_bf16 v[208:211], v[28:31], v[64:67], v[208:211]
  v_mfma_f32_16x16x32_bf16 v[212:215], v[28:31], v[68:71], v[212:215]
  v_mfma_f32_16x16x32_bf16 v[216:219], v[28:31], v[72:75], v[216:219]
  v_mfma_f32_16x16x32_bf16 v[220:223], v[28:31], v[76:79], v[220:223]
  v_mfma_f32_16x16x32_bf16 v[224:227], v[32:35], v[64:67], v[224:227]
  v_mfma_f32_16x16x32_bf16 v[228:231], v[32:35], v[68:71], v[228:231]
  v_mfma_f32_16x16x32_bf16 v[232:235], v[32:35], v[72:75], v[232:235]
  v_mfma_f32_16x16x32_bf16 v[236:239], v[32:35], v[76:79], v[236:239]
  s_add_u32 s58, s58, 45056
  s_cmp_eq_u32 s58, 135168
  s_cselect_b32 s58, 0, s58
  s_waitcnt lgkmcnt(0)
  s_barrier
  v_mfma_f32_16x16x32_bf16 v[128:131], v[80:83], v[36:39], v[128:131]
  v_add_u32 v112, s58, v105
  v_mfma_f32_16x16x32_bf16 v[132:135], v[84:87], v[36:39], v[132:135]
  v_add_u32 v113, s58, v106
  v_mfma_f32_16x16x32_bf16 v[136:139], v[88:91], v[36:39], v[136:139]
  v_add_u32 v114, s58, v107
  v_mfma_f32_16x16x32_bf16 v[140:143], v[92:95], v[36:39], v[140:143]
  v_add_u32 v115, s58, v108
  v_mfma_f32_16x16x32_bf16 v[144:147], v[80:83], v[40:43], v[144:147]
  ds_read_b64_tr_b16 v[8:9], v115 offset:96
  v_mfma_f32_16x16x32_bf16 v[148:151], v[84:87], v[40:43], v[148:151]
  ds_read_b64_tr_b16 v[10:11], v115 offset:3680
  v_mfma_f32_16x16x32_bf16 v[152:155], v[88:91], v[40:43], v[152:155]
  ds_read_b128 v[64:67], v112 offset:0
  v_mfma_f32_16x16x32_bf16 v[156:159], v[92:95], v[40:43], v[156:159]
  ds_read_b128 v[68:71], v112 offset:2048
  v_mfma_f32_16x16x32_bf16 v[160:163], v[80:83], v[44:47], v[160:163]
  ds_read_b128 v[72:75], v112 offset:4096
  v_mfma_f32_16x16x32_bf16 v[164:167], v[84:87], v[44:47], v[164:167]
  ds_read_b128 v[76:79], v112 offset:6144
  v_mfma_f32_16x16x32_bf16 v[168:171], v[88:91], v[44:47], v[168:171]
  ds_read_b64_tr_b16 v[12:13], v114 offset:128
  v_mfma_f32_16x16x32_bf16 v[172:175], v[92:95], v[44:47], v[172:175]
  ds_read_b64_tr_b16 v[14:15], v114 offset:3712
  v_mfma_f32_16x16x32_bf16 v[176:179], v[80:83], v[48:51], v[176:179]
  ds_read_b64_tr_b16 v[16:17], v115 offset:224
  v_mfma_f32_16x16x32_bf16 v[180:183], v[84:87], v[48:51], v[180:183]
  ds_read_b64_tr_b16 v[18:19], v115 offset:3808
  v_mfma_f32_16x16x32_bf16 v[184:187], v[88:91], v[48:51], v[184:187]
  ds_read_b64_tr_b16 v[20:21], v114 offset:256
  v_mfma_f32_16x16x32_bf16 v[188:191], v[92:95], v[48:51], v[188:191]
  ds_read_b64_tr_b16 v[22:23], v114 offset:3840
  v_mfma_f32_16x16x32_bf16 v[192:195], v[80:83], v[52:55], v[192:195]
  ds_read_b64_tr_b16 v[24:25], v115 offset:288
  v_mfma_f32_16x16x32_bf16 v[196:199], v[84:87], v[52:55], v[196:199]
  ds_read_b64_tr_b16 v[26:27], v115 offset:3872
  v_mfma_f32_16x16x32_bf16 v[200:203], v[88:91], v[52:55], v[200:203]
  ds_read_b64_tr_b16 v[28:29], v114 offset:384
  v_mfma_f32_16x16x32_bf16 v[204:207], v[92:95], v[52:55], v[204:207]
  ds_read_b64_tr_b16 v[30:31], v114 offset:3968
  v_mfma_f32_16x16x32_bf16 v[208:211], v[56:59], v[80:83], v[208:211]
  ds_read_b64_tr_b16 v[32:33], v115 offset:416
  v_mfma_f32_16x16x32_bf16 v[212:215], v[56:59], v[84:87], v[212:215]
  ds_read_b64_tr_b16 v[34:35], v115 offset:4000
  v_mfma_f32_16x16x32_bf16 v[216:219], v[56:59], v[88:91], v[216:219]
  v_mfma_f32_16x16x32_bf16 v[220:223], v[56:59], v[92:95], v[220:223]
  v_mfma_f32_16x16x32_bf16 v[224:227], v[60:63], v[80:83], v[224:227]
  v_mfma_f32_16x16x32_bf16 v[228:231], v[60:63], v[84:87], v[228:231]
  v_mfma_f32_16x16x32_bf16 v[232:235], v[60:63], v[88:91], v[232:235]
  v_mfma_f32_16x16x32_bf16 v[236:239], v[60:63], v[92:95], v[236:239]
  s_add_u32 s59, s59, 1
  s_cmp_lt_u32 s59, 10
  s_waitcnt lgkmcnt(0)
  s_cbranch_scc1 L_s1_loop_A1
  v_and_b32 v2, 15, v1
  v_lshrrev_b32 v3, 4, v1
  s_lshl_b32 s60, s32, 7
  s_lshl_b32 s63, s52, 6
  s_add_u32 s60, s60, s63
  v_mul_u32_u24 v5, 272, v2
  v_lshlrev_b32 v6, 3, v3
  s_lshl_b32 s63, s52, 7
  v_add3_u32 v5, v5, v6, s63
  v_pk_mul_f32 v[96:97], v[128:129], s[78:79]
  v_pk_mul_f32 v[98:99], v[130:131], s[78:79]
  v_pk_mul_f32 v[100:101], v[132:133], s[78:79]
  v_pk_mul_f32 v[102:103], v[134:135], s[78:79]
  v_pk_mul_f32 v[104:105], v[136:137], s[78:79]
  v_pk_mul_f32 v[106:107], v[138:139], s[78:79]
  v_pk_mul_f32 v[108:109], v[140:141], s[78:79]
  v_pk_mul_f32 v[110:111], v[142:143], s[78:79]
  v_exp_f32_e64 v96, v96 clamp
  v_max_f32 v128, s80, v128
  v_exp_f32_e64 v97, v97 clamp
  v_max_f32 v129, s80, v129
  v_exp_f32_e64 v98, v98 clamp
  v_max_f32 v130, s80, v130
  v_exp_f32_e64 v99, v99 clamp
  v_max_f32 v131, s80, v131
  v_exp_f32_e64 v100, v100 clamp
  v_max_f32 v132, s80, v132
  v_exp_f32_e64 v101, v101 clamp
  v_max_f32 v133, s80, v133
  v_exp_f32_e64 v102, v102 clamp
  v_max_f32 v134, s80, v134
  v_exp_f32_e64 v103, v103 clamp
  v_max_f32 v135, s80, v135
  v_exp_f32_e64 v104, v104 clamp
  v_max_f32 v136, s80, v136
  v_exp_f32_e64 v105, v105 clamp
  v_max_f32 v137, s80, v137
  v_exp_f32_e64 v106, v106 clamp
  v_max_f32 v138, s80, v138
  v_exp_f32_e64 v107, v107 clamp
  v_max_f32 v139, s80, v139
  v_exp_f32_e64 v108, v108 clamp
  v_max_f32 v140, s80, v140
  v_exp_f32_e64 v109, v109 clamp
  v_max_f32 v141, s80, v141
  v_exp_f32_e64 v110, v110 clamp
  v_max_f32 v142, s80, v142
  v_exp_f32_e64 v111, v111 clamp
  v_max_f32 v143, s80, v143
  v_pk_add_f32 v[128:129], v[128:129], v[96:97]
  v_pk_add_f32 v[130:131], v[130:131], v[98:99]
  v_pk_add_f32 v[132:133], v[132:133], v[100:101]
  v_pk_add_f32 v[134:135], v[134:135], v[102:103]
  v_pk_add_f32 v[136:137], v[136:137], v[104:105]
  v_pk_add_f32 v[138:139], v[138:139], v[106:107]
  v_pk_add_f32 v[140:141], v[140:141], v[108:109]
  v_pk_add_f32 v[142:143], v[142:143], v[110:111]
  v_cvt_pk_bf16_f32 v128, v128, v129
  v_cvt_pk_bf16_f32 v129, v130, v131
  ds_write_b64 v5, v[128:129] offset:13056
  v_cvt_pk_bf16_f32 v132, v132, v133
  v_cvt_pk_bf16_f32 v133, v134, v135
  ds_write_b64 v5, v[132:133] offset:13088
  v_cvt_pk_bf16_f32 v136, v136, v137
  v_cvt_pk_bf16_f32 v137, v138, v139
  ds_write_b64 v5, v[136:137] offset:13120
  v_cvt_pk_bf16_f32 v140, v140, v141
  v_cvt_pk_bf16_f32 v141, v142, v143
  ds_write_b64 v5, v[140:141] offset:13152
  v_pk_mul_f32 v[96:97], v[144:145], s[78:79]
  v_pk_mul_f32 v[98:99], v[146:147], s[78:79]
  v_pk_mul_f32 v[100:101], v[148:149], s[78:79]
  v_pk_mul_f32 v[102:103], v[150:151], s[78:79]
  v_pk_mul_f32 v[104:105], v[152:153], s[78:79]
  v_pk_mul_f32 v[106:107], v[154:155], s[78:79]
  v_pk_mul_f32 v[108:109], v[156:157], s[78:79]
  v_pk_mul_f32 v[110:111], v[158:159], s[78:79]
  v_exp_f32_e64 v96, v96 clamp
  v_max_f32 v144, s80, v144
  v_exp_f32_e64 v97, v97 clamp
  v_max_f32 v145, s80, v145
  v_exp_f32_e64 v98, v98 clamp
  v_max_f32 v146, s80, v146
  v_exp_f32_e64 v99, v99 clamp
  v_max_f32 v147, s80, v147
  v_exp_f32_e64 v100, v100 clamp
  v_max_f32 v148, s80, v148
  v_exp_f32_e64 v101, v101 clamp
  v_max_f32 v149, s80, v149
  v_exp_f32_e64 v102, v102 clamp
  v_max_f32 v150, s80, v150
  v_exp_f32_e64 v103, v103 clamp
  v_max_f32 v151, s80, v151
  v_exp_f32_e64 v104, v104 clamp
  v_max_f32 v152, s80, v152
  v_exp_f32_e64 v105, v105 clamp
  v_max_f32 v153, s80, v153
  v_exp_f32_e64 v106, v106 clamp
  v_max_f32 v154, s80, v154
  v_exp_f32_e64 v107, v107 clamp
  v_max_f32 v155, s80, v155
  v_exp_f32_e64 v108, v108 clamp
  v_max_f32 v156, s80, v156
  v_exp_f32_e64 v109, v109 clamp
  v_max_f32 v157, s80, v157
  v_exp_f32_e64 v110, v110 clamp
  v_max_f32 v158, s80, v158
  v_exp_f32_e64 v111, v111 clamp
  v_max_f32 v159, s80, v159
  v_pk_add_f32 v[144:145], v[144:145], v[96:97]
  v_pk_add_f32 v[146:147], v[146:147], v[98:99]
  v_pk_add_f32 v[148:149], v[148:149], v[100:101]
  v_pk_add_f32 v[150:151], v[150:151], v[102:103]
  v_pk_add_f32 v[152:153], v[152:153], v[104:105]
  v_pk_add_f32 v[154:155], v[154:155], v[106:107]
  v_pk_add_f32 v[156:157], v[156:157], v[108:109]
  v_pk_add_f32 v[158:159], v[158:159], v[110:111]
  v_cvt_pk_bf16_f32 v144, v144, v145
  v_cvt_pk_bf16_f32 v145, v146, v147
  ds_write_b64 v5, v[144:145] offset:17408
  v_cvt_pk_bf16_f32 v148, v148, v149
  v_cvt_pk_bf16_f32 v149, v150, v151
  ds_write_b64 v5, v[148:149] offset:17440
  v_cvt_pk_bf16_f32 v152, v152, v153
  v_cvt_pk_bf16_f32 v153, v154, v155
  ds_write_b64 v5, v[152:153] offset:17472
  v_cvt_pk_bf16_f32 v156, v156, v157
  v_cvt_pk_bf16_f32 v157, v158, v159
  ds_write_b64 v5, v[156:157] offset:17504
  v_cvt_pk_bf16_f32 v160, v160, v161
  v_cvt_pk_bf16_f32 v161, v162, v163
  ds_write_b64 v5, v[160:161] offset:30464
  v_cvt_pk_bf16_f32 v164, v164, v165
  v_cvt_pk_bf16_f32 v165, v166, v167
  ds_write_b64 v5, v[164:165] offset:30496
  v_cvt_pk_bf16_f32 v168, v168, v169
  v_cvt_pk_bf16_f32 v169, v170, v171
  ds_write_b64 v5, v[168:169] offset:30528
  v_cvt_pk_bf16_f32 v172, v172, v173
  v_cvt_pk_bf16_f32 v173, v174, v175
  ds_write_b64 v5, v[172:173] offset:30560
  v_cvt_pk_bf16_f32 v176, v176, v177
  v_cvt_pk_bf16_f32 v177, v178, v179
  ds_write_b64 v5, v[176:177] offset:34816
  v_cvt_pk_bf16_f32 v180, v180, v181
  v_cvt_pk_bf16_f32 v181, v182, v183
  ds_write_b64 v5, v[180:181] offset:34848
  v_cvt_pk_bf16_f32 v184, v184, v185
  v_cvt_pk_bf16_f32 v185, v186, v187
  ds_write_b64 v5, v[184:185] offset:34880
  v_cvt_pk_bf16_f32 v188, v188, v189
  v_cvt_pk_bf16_f32 v189, v190, v191
  ds_write_b64 v5, v[188:189] offset:34912
  v_cvt_pk_bf16_f32 v192, v192, v193
  v_cvt_pk_bf16_f32 v193, v194, v195
  ds_write_b64 v5, v[192:193] offset:39168
  v_cvt_pk_bf16_f32 v196, v196, v197
  v_cvt_pk_bf16_f32 v197, v198, v199
  ds_write_b64 v5, v[196:197] offset:39200
  v_cvt_pk_bf16_f32 v200, v200, v201
  v_cvt_pk_bf16_f32 v201, v202, v203
  ds_write_b64 v5, v[200:201] offset:39232
  v_cvt_pk_bf16_f32 v204, v204, v205
  v_cvt_pk_bf16_f32 v205, v206, v207
  ds_write_b64 v5, v[204:205] offset:39264
  s_lshl_b32 s63, s33, 4
  s_add_u32 s63, s63, 8
  s_lshr_b32 s64, s60, 4
  s_mul_i32 s64, s64, 160
  s_add_u32 s63, s63, s64
  s_lshl_b32 s63, s63, 7
  s_add_u32 s63, s63, 0x600000
  v_lshlrev_b32 v7, 3, v1
  v_pk_mul_f32 v[96:97], v[208:209], s[78:79]
  v_pk_mul_f32 v[98:99], v[210:211], s[78:79]
  v_pk_mul_f32 v[100:101], v[212:213], s[78:79]
  v_pk_mul_f32 v[102:103], v[214:215], s[78:79]
  v_pk_mul_f32 v[104:105], v[216:217], s[78:79]
  v_pk_mul_f32 v[106:107], v[218:219], s[78:79]
  v_pk_mul_f32 v[108:109], v[220:221], s[78:79]
  v_pk_mul_f32 v[110:111], v[222:223], s[78:79]
  v_exp_f32_e64 v96, v96 clamp
  v_max_f32 v208, s80, v208
  v_exp_f32_e64 v97, v97 clamp
  v_max_f32 v209, s80, v209
  v_exp_f32_e64 v98, v98 clamp
  v_max_f32 v210, s80, v210
  v_exp_f32_e64 v99, v99 clamp
  v_max_f32 v211, s80, v211
  v_exp_f32_e64 v100, v100 clamp
  v_max_f32 v212, s80, v212
  v_exp_f32_e64 v101, v101 clamp
  v_max_f32 v213, s80, v213
  v_exp_f32_e64 v102, v102 clamp
  v_max_f32 v214, s80, v214
  v_exp_f32_e64 v103, v103 clamp
  v_max_f32 v215, s80, v215
  v_exp_f32_e64 v104, v104 clamp
  v_max_f32 v216, s80, v216
  v_exp_f32_e64 v105, v105 clamp
  v_max_f32 v217, s80, v217
  v_exp_f32_e64 v106, v106 clamp
  v_max_f32 v218, s80, v218
  v_exp_f32_e64 v107, v107 clamp
  v_max_f32 v219, s80, v219
  v_exp_f32_e64 v108, v108 clamp
  v_max_f32 v220, s80, v220
  v_exp_f32_e64 v109, v109 clamp
  v_max_f32 v221, s80, v221
  v_exp_f32_e64 v110, v110 clamp
  v_max_f32 v222, s80, v222
  v_exp_f32_e64 v111, v111 clamp
  v_max_f32 v223, s80, v223
  v_pk_add_f32 v[208:209], v[208:209], v[96:97]
  v_pk_add_f32 v[210:211], v[210:211], v[98:99]
  v_pk_add_f32 v[212:213], v[212:213], v[100:101]
  v_pk_add_f32 v[214:215], v[214:215], v[102:103]
  v_pk_add_f32 v[216:217], v[216:217], v[104:105]
  v_pk_add_f32 v[218:219], v[218:219], v[106:107]
  v_pk_add_f32 v[220:221], v[220:221], v[108:109]
  v_pk_add_f32 v[222:223], v[222:223], v[110:111]
  v_cvt_pk_bf16_f32 v208, v208, v209
  v_cvt_pk_bf16_f32 v209, v210, v211
  s_add_u32 s64, s63, 0
  buffer_store_dwordx2 v[208:209], v7, s[20:23], s64 offen
  v_cvt_pk_bf16_f32 v212, v212, v213
  v_cvt_pk_bf16_f32 v213, v214, v215
  s_add_u32 s64, s63, 20480
  buffer_store_dwordx2 v[212:213], v7, s[20:23], s64 offen
  v_cvt_pk_bf16_f32 v216, v216, v217
  v_cvt_pk_bf16_f32 v217, v218, v219
  s_add_u32 s64, s63, 40960
  buffer_store_dwordx2 v[216:217], v7, s[20:23], s64 offen
  v_cvt_pk_bf16_f32 v220, v220, v221
  v_cvt_pk_bf16_f32 v221, v222, v223
  s_add_u32 s64, s63, 61440
  buffer_store_dwordx2 v[220:221], v7, s[20:23], s64 offen
  s_waitcnt lgkmcnt(0)
  s_barrier
  s_mul_i32 s63, s35, 5440
  v_mul_u32_u24 v5, 272, v2
  v_lshlrev_b32 v6, 4, v3
  v_add3_u32 v5, v5, v6, s63
  ds_read_b128 v[16:19], v5 offset:0
  ds_read_b128 v[20:23], v5 offset:4352
  ds_read_b128 v[24:27], v5 offset:21760
  ds_read_b128 v[28:31], v5 offset:26112
  ds_read_b128 v[32:35], v5 offset:64
  ds_read_b128 v[36:39], v5 offset:4416
  ds_read_b128 v[40:43], v5 offset:21824
  ds_read_b128 v[44:47], v5 offset:26176
  ds_read_b128 v[48:51], v5 offset:128
  ds_read_b128 v[52:55], v5 offset:4480
  ds_read_b128 v[56:59], v5 offset:21888
  ds_read_b128 v[60:63], v5 offset:26240
  ds_read_b128 v[64:67], v5 offset:192
  ds_read_b128 v[68:71], v5 offset:4544
  ds_read_b128 v[72:75], v5 offset:21952
  ds_read_b128 v[76:79], v5 offset:26304
  s_lshl_b32 s63, s33, 4
  s_add_u32 s63, s63, 12
  s_lshr_b32 s64, s60, 4
  s_mul_i32 s64, s64, 160
  s_add_u32 s63, s63, s64
  s_lshl_b32 s63, s63, 7
  s_add_u32 s63, s63, 0x600000
  v_lshlrev_b32 v7, 3, v1
  v_pk_mul_f32 v[96:97], v[224:225], s[78:79]
  v_pk_mul_f32 v[98:99], v[226:227], s[78:79]
  v_pk_mul_f32 v[100:101], v[228:229], s[78:79]
  v_pk_mul_f32 v[102:103], v[230:231], s[78:79]
  v_pk_mul_f32 v[104:105], v[232:233], s[78:79]
  v_pk_mul_f32 v[106:107], v[234:235], s[78:79]
  v_pk_mul_f32 v[108:109], v[236:237], s[78:79]
  v_pk_mul_f32 v[110:111], v[238:239], s[78:79]
  v_exp_f32_e64 v96, v96 clamp
  v_max_f32 v224, s80, v224
  v_exp_f32_e64 v97, v97 clamp
  v_max_f32 v225, s80, v225
  v_exp_f32_e64 v98, v98 clamp
  v_max_f32 v226, s80, v226
  v_exp_f32_e64 v99, v99 clamp
  v_max_f32 v227, s80, v227
  v_exp_f32_e64 v100, v100 clamp
  v_max_f32 v228, s80, v228
  v_exp_f32_e64 v101, v101 clamp
  v_max_f32 v229, s80, v229
  v_exp_f32_e64 v102, v102 clamp
  v_max_f32 v230, s80, v230
  v_exp_f32_e64 v103, v103 clamp
  v_max_f32 v231, s80, v231
  v_exp_f32_e64 v104, v104 clamp
  v_max_f32 v232, s80, v232
  v_exp_f32_e64 v105, v105 clamp
  v_max_f32 v233, s80, v233
  v_exp_f32_e64 v106, v106 clamp
  v_max_f32 v234, s80, v234
  v_exp_f32_e64 v107, v107 clamp
  v_max_f32 v235, s80, v235
  v_exp_f32_e64 v108, v108 clamp
  v_max_f32 v236, s80, v236
  v_exp_f32_e64 v109, v109 clamp
  v_max_f32 v237, s80, v237
  v_exp_f32_e64 v110, v110 clamp
  v_max_f32 v238, s80, v238
  v_exp_f32_e64 v111, v111 clamp
  v_max_f32 v239, s80, v239
  v_pk_add_f32 v[224:225], v[224:225], v[96:97]
  v_pk_add_f32 v[226:227], v[226:227], v[98:99]
  v_pk_add_f32 v[228:229], v[228:229], v[100:101]
  v_pk_add_f32 v[230:231], v[230:231], v[102:103]
  v_pk_add_f32 v[232:233], v[232:233], v[104:105]
  v_pk_add_f32 v[234:235], v[234:235], v[106:107]
  v_pk_add_f32 v[236:237], v[236:237], v[108:109]
  v_pk_add_f32 v[238:239], v[238:239], v[110:111]
  v_cvt_pk_bf16_f32 v224, v224, v225
  v_cvt_pk_bf16_f32 v225, v226, v227
  s_add_u32 s64, s63, 0
  buffer_store_dwordx2 v[224:225], v7, s[20:23], s64 offen
  v_cvt_pk_bf16_f32 v228, v228, v229
  v_cvt_pk_bf16_f32 v229, v230, v231
  s_add_u32 s64, s63, 20480
  buffer_store_dwordx2 v[228:229], v7, s[20:23], s64 offen
  v_cvt_pk_bf16_f32 v232, v232, v233
  v_cvt_pk_bf16_f32 v233, v234, v235
  s_add_u32 s64, s63, 40960
  buffer_store_dwordx2 v[232:233], v7, s[20:23], s64 offen
  v_cvt_pk_bf16_f32 v236, v236, v237
  v_cvt_pk_bf16_f32 v237, v238, v239
  s_add_u32 s64, s63, 61440
  buffer_store_dwordx2 v[236:237], v7, s[20:23], s64 offen
  v_cmp_eq_u32 vcc, 4, v2
  v_mov_b32 v6, 0x3f803f80
  s_waitcnt lgkmcnt(0)
  v_cndmask_b32 v28, v28, v6, vcc
  v_cndmask_b32 v29, v29, v6, vcc
  v_cndmask_b32 v30, v30, v6, vcc
  v_cndmask_b32 v31, v31, v6, vcc
  v_cndmask_b32 v44, v44, v6, vcc
  v_cndmask_b32 v45, v45, v6, vcc
  v_cndmask_b32 v46, v46, v6, vcc
  v_cndmask_b32 v47, v47, v6, vcc
  v_cndmask_b32 v60, v60, v6, vcc
  v_cndmask_b32 v61, v61, v6, vcc
  v_cndmask_b32 v62, v62, v6, vcc
  v_cndmask_b32 v63, v63, v6, vcc
  v_cndmask_b32 v76, v76, v6, vcc
  v_cndmask_b32 v77, v77, v6, vcc
  v_cndmask_b32 v78, v78, v6, vcc
  v_cndmask_b32 v79, v79, v6, vcc
  s_nop 1
  v_mfma_f32_16x16x32_bf16 v[80:83], v[16:19], v[24:27], 0
  v_mfma_f32_16x16x32_bf16 v[84:87], v[16:19], v[28:31], 0
  v_mfma_f32_16x16x32_bf16 v[88:91], v[20:23], v[24:27], 0
  v_mfma_f32_16x16x32_bf16 v[92:95], v[20:23], v[28:31], 0
  v_mfma_f32_16x16x32_bf16 v[80:83], v[32:35], v[40:43], v[80:83]
  v_mfma_f32_16x16x32_bf16 v[84:87], v[32:35], v[44:47], v[84:87]
  v_mfma_f32_16x16x32_bf16 v[88:91], v[36:39], v[40:43], v[88:91]
  v_mfma_f32_16x16x32_bf16 v[92:95], v[36:39], v[44:47], v[92:95]
  v_mfma_f32_16x16x32_bf16 v[80:83], v[48:51], v[56:59], v[80:83]
  v_mfma_f32_16x16x32_bf16 v[84:87], v[48:51], v[60:63], v[84:87]
  v_mfma_f32_16x16x32_bf16 v[88:91], v[52:55], v[56:59], v[88:91]
  v_mfma_f32_16x16x32_bf16 v[92:95], v[52:55], v[60:63], v[92:95]
  v_mfma_f32_16x16x32_bf16 v[80:83], v[64:67], v[72:75], v[80:83]
  v_mfma_f32_16x16x32_bf16 v[84:87], v[64:67], v[76:79], v[84:87]
  v_mfma_f32_16x16x32_bf16 v[88:91], v[68:71], v[72:75], v[88:91]
  v_mfma_f32_16x16x32_bf16 v[92:95], v[68:71], v[76:79], v[92:95]
  s_lshl_b32 s63, s32, 5
  s_lshl_b32 s64, s33, 2
  s_add_u32 s63, s63, s64
  s_add_u32 s63, s63, s35
  s_mul_i32 s63, s63, 1680
  s_add_u32 s63, s63, 0x900000
  v_mul_u32_u24 v5, 80, v2
  v_lshlrev_b32 v6, 4, v3
  v_add_u32 v5, v5, v6
  v_cmp_eq_u32 s[74:75], 0, v3
  v_cmp_gt_u32 s[76:77], 5, v2
  s_nop 7
  buffer_store_dwordx4 v[80:83], v5, s[20:23], s63 offen
  s_and_saveexec_b64 s[72:73], s[74:75]
  buffer_store_dwordx4 v[88:91], v5, s[20:23], s63 offen offset:64
  s_mov_b64 exec, s[76:77]
  buffer_store_dwordx4 v[84:87], v5, s[20:23], s63 offen offset:1280
  s_and_b64 exec, exec, s[74:75]
  buffer_store_dwordx4 v[92:95], v5, s[20:23], s63 offen offset:1344
  s_mov_b64 exec, s[72:73]
  s_endpgm
L_s1_typeB:
  v_mul_u32_u24 v2, 384, v6
  v_add_u32 v2, v2, v5
  v_add_u32 v2, 16384, v2
  v_lshrrev_b32 v7, 1, v6
  v_and_b32 v7, 3, v7
  v_xor_b32 v3, 0, v7
  v_subrev_u32 v3, 0, v3
  v_lshlrev_b32 v3, 5, v3
  v_add_u32 v107, v2, v3
  v_xor_b32 v3, 1, v7
  v_subrev_u32 v3, 1, v3
  v_lshlrev_b32 v3, 5, v3
  v_add_u32 v108, v2, v3
  v_xor_b32 v3, 2, v7
  v_subrev_u32 v3, 2, v3
  v_lshlrev_b32 v3, 5, v3
  v_add_u32 v109, v2, v3
  v_xor_b32 v3, 3, v7
  v_subrev_u32 v3, 3, v3
  v_lshlrev_b32 v3, 5, v3
  v_add_u32 v110, v2, v3
  v_lshlrev_b32 v2, 5, v6
  v_add_u32 v2, v2, v5
  v_add_u32 v111, 40960, v2
  s_cmp_eq_u32 s53, 1
  s_cbranch_scc1 L_s1_B1
  s_waitcnt vmcnt(8)
  v_lshlrev_b32 v128, 16, v32
  v_and_b32 v129, 0xffff0000, v32
  v_lshlrev_b32 v130, 16, v33
  v_and_b32 v131, 0xffff0000, v33
  v_pk_mov_b32 v[132:133], v[128:129], v[128:129] op_sel:[0,1]
  v_pk_mov_b32 v[134:135], v[130:131], v[130:131] op_sel:[0,1]
  v_pk_mov_b32 v[136:137], v[128:129], v[128:129] op_sel:[0,1]
  v_pk_mov_b32 v[138:139], v[130:131], v[130:131] op_sel:[0,1]
  v_pk_mov_b32 v[140:141], v[128:129], v[128:129] op_sel:[0,1]
  v_pk_mov_b32 v[142:143], v[130:131], v[130:131] op_sel:[0,1]
  v_lshlrev_b32 v144, 16, v34
  v_and_b32 v145, 0xffff0000, v34
  v_lshlrev_b32 v146, 16, v35
  v_and_b32 v147, 0xffff0000, v35
  v_pk_mov_b32 v[148:149], v[144:145], v[144:145] op_sel:[0,1]
  v_pk_mov_b32 v[150:151], v[146:147], v[146:147] op_sel:[0,1]
  v_pk_mov_b32 v[152:153], v[144:145], v[144:145] op_sel:[0,1]
  v_pk_mov_b32 v[154:155], v[146:147], v[146:147] op_sel:[0,1]
  v_pk_mov_b32 v[156:157], v[144:145], v[144:145] op_sel:[0,1]
  v_pk_mov_b32 v[158:159], v[146:147], v[146:147] op_sel:[0,1]
  v_lshlrev_b32 v160, 16, v36
  v_and_b32 v161, 0xffff0000, v36
  v_lshlrev_b32 v162, 16, v37
  v_and_b32 v163, 0xffff0000, v37
  v_pk_mov_b32 v[164:165], v[160:161], v[160:161] op_sel:[0,1]
  v_pk_mov_b32 v[166:167], v[162:163], v[162:163] op_sel:[0,1]
  v_pk_mov_b32 v[168:169], v[160:161], v[160:161] op_sel:[0,1]
  v_pk_mov_b32 v[170:171], v[162:163], v[162:163] op_sel:[0,1]
  v_pk_mov_b32 v[172:173], v[160:161], v[160:161] op_sel:[0,1]
  v_pk_mov_b32 v[174:175], v[162:163], v[162:163] op_sel:[0,1]
  v_lshlrev_b32 v176, 16, v38
  v_and_b32 v177, 0xffff0000, v38
  v_lshlrev_b32 v178, 16, v39
  v_and_b32 v179, 0xffff0000, v39
  v_pk_mov_b32 v[180:181], v[176:177], v[176:177] op_sel:[0,1]
  v_pk_mov_b32 v[182:183], v[178:179], v[178:179] op_sel:[0,1]
  v_pk_mov_b32 v[184:185], v[176:177], v[176:177] op_sel:[0,1]
  v_pk_mov_b32 v[186:187], v[178:179], v[178:179] op_sel:[0,1]
  v_pk_mov_b32 v[188:189], v[176:177], v[176:177] op_sel:[0,1]
  v_pk_mov_b32 v[190:191], v[178:179], v[178:179] op_sel:[0,1]
  v_lshlrev_b32 v192, 16, v40
  v_and_b32 v193, 0xffff0000, v40
  v_lshlrev_b32 v194, 16, v41
  v_and_b32 v195, 0xffff0000, v41
  v_pk_mov_b32 v[196:197], v[192:193], v[192:193] op_sel:[0,1]
  v_pk_mov_b32 v[198:199], v[194:195], v[194:195] op_sel:[0,1]
  v_pk_mov_b32 v[200:201], v[192:193], v[192:193] op_sel:[0,1]
  v_pk_mov_b32 v[202:203], v[194:195], v[194:195] op_sel:[0,1]
  v_pk_mov_b32 v[204:205], v[192:193], v[192:193] op_sel:[0,1]
  v_pk_mov_b32 v[206:207], v[194:195], v[194:195] op_sel:[0,1]
  v_lshlrev_b32 v208, 16, v42
  v_and_b32 v209, 0xffff0000, v42
  v_lshlrev_b32 v210, 16, v43
  v_and_b32 v211, 0xffff0000, v43
  v_pk_mov_b32 v[212:213], v[208:209], v[208:209] op_sel:[0,1]
  v_pk_mov_b32 v[214:215], v[210:211], v[210:211] op_sel:[0,1]
  v_pk_mov_b32 v[216:217], v[208:209], v[208:209] op_sel:[0,1]
  v_pk_mov_b32 v[218:219], v[210:211], v[210:211] op_sel:[0,1]
  v_pk_mov_b32 v[220:221], v[208:209], v[208:209] op_sel:[0,1]
  v_pk_mov_b32 v[222:223], v[210:211], v[210:211] op_sel:[0,1]
  v_pk_mov_b32 v[224:225], s[80:81], s[80:81] op_sel:[0,1]
  v_pk_mov_b32 v[226:227], s[80:81], s[80:81] op_sel:[0,1]
  v_pk_mov_b32 v[228:229], s[80:81], s[80:81] op_sel:[0,1]
  v_pk_mov_b32 v[230:231], s[80:81], s[80:81] op_sel:[0,1]
  v_pk_mov_b32 v[232:233], s[80:81], s[80:81] op_sel:[0,1]
  v_pk_mov_b32 v[234:235], s[80:81], s[80:81] op_sel:[0,1]
  v_pk_mov_b32 v[236:237], s[80:81], s[80:81] op_sel:[0,1]
  v_pk_mov_b32 v[238:239], s[80:81], s[80:81] op_sel:[0,1]
  v_add_u32 v112, s58, v105
  v_add_u32 v113, s58, v106
  v_add_u32 v114, s58, v107
  v_add_u32 v115, s58, v108
  v_add_u32 v116, s58, v109
  v_add_u32 v117, s58, v110
  v_add_u32 v118, s58, v111
  s_barrier
  ds_read_b64_tr_b16 v[8:9], v114 offset:0
  ds_read_b64_tr_b16 v[10:11], v114 offset:3072
  ds_read_b128 v[64:67], v112 offset:0
  ds_read_b128 v[68:71], v112 offset:2048
  ds_read_b128 v[72:75], v112 offset:4096
  ds_read_b128 v[76:79], v112 offset:6144
  ds_read_b64_tr_b16 v[12:13], v115 offset:32
  ds_read_b64_tr_b16 v[14:15], v115 offset:3104
  ds_read_b64_tr_b16 v[16:17], v116 offset:64
  ds_read_b64_tr_b16 v[18:19], v116 offset:3136
  ds_read_b64_tr_b16 v[20:21], v117 offset:96
  ds_read_b64_tr_b16 v[22:23], v117 offset:3168
  ds_read_b64_tr_b16 v[24:25], v114 offset:128
  ds_read_b64_tr_b16 v[26:27], v114 offset:3200
  ds_read_b64_tr_b16 v[28:29], v115 offset:160
  ds_read_b64_tr_b16 v[30:31], v115 offset:3232
  ds_read_b64_tr_b16 v[32:33], v118 offset:0
  ds_read_b64_tr_b16 v[34:35], v118 offset:256
  s_waitcnt lgkmcnt(0)
L_s1_loop_B0:
  v_mfma_f32_16x16x32_bf16 v[128:131], v[8:11], v[64:67], v[128:131]
  ds_read_b64_tr_b16 v[36:37], v114 offset:12288
  v_mfma_f32_16x16x32_bf16 v[132:135], v[8:11], v[68:71], v[132:135]
  ds_read_b64_tr_b16 v[38:39], v114 offset:15360
  v_mfma_f32_16x16x32_bf16 v[136:139], v[8:11], v[72:75], v[136:139]
  ds_read_b128 v[80:83], v113 offset:0
  v_mfma_f32_16x16x32_bf16 v[140:143], v[8:11], v[76:79], v[140:143]
  ds_read_b128 v[84:87], v113 offset:2048
  v_mfma_f32_16x16x32_bf16 v[144:147], v[12:15], v[64:67], v[144:147]
  ds_read_b128 v[88:91], v113 offset:4096
  v_mfma_f32_16x16x32_bf16 v[148:151], v[12:15], v[68:71], v[148:151]
  ds_read_b128 v[92:95], v113 offset:6144
  v_mfma_f32_16x16x32_bf16 v[152:155], v[12:15], v[72:75], v[152:155]
  ds_read_b64_tr_b16 v[40:41], v115 offset:12320
  v_mfma_f32_16x16x32_bf16 v[156:159], v[12:15], v[76:79], v[156:159]
  ds_read_b64_tr_b16 v[42:43], v115 offset:15392
  v_mfma_f32_16x16x32_bf16 v[160:163], v[16:19], v[64:67], v[160:163]
  ds_read_b64_tr_b16 v[44:45], v116 offset:12352
  v_mfma_f32_16x16x32_bf16 v[164:167], v[16:19], v[68:71], v[164:167]
  ds_read_b64_tr_b16 v[46:47], v116 offset:15424
  v_mfma_f32_16x16x32_bf16 v[168:171], v[16:19], v[72:75], v[168:171]
  ds_read_b64_tr_b16 v[48:49], v117 offset:12384
  v_mfma_f32_16x16x32_bf16 v[172:175], v[16:19], v[76:79], v[172:175]
  ds_read_b64_tr_b16 v[50:51], v117 offset:15456
  v_mfma_f32_16x16x32_bf16 v[176:179], v[20:23], v[64:67], v[176:179]
  ds_read_b64_tr_b16 v[52:53], v114 offset:12416
  v_mfma_f32_16x16x32_bf16 v[180:183], v[20:23], v[68:71], v[180:183]
  ds_read_b64_tr_b16 v[54:55], v114 offset:15488
  v_mfma_f32_16x16x32_bf16 v[184:187], v[20:23], v[72:75], v[184:187]
  ds_read_b64_tr_b16 v[56:57], v115 offset:12448
  v_mfma_f32_16x16x32_bf16 v[188:191], v[20:23], v[76:79], v[188:191]
  ds_read_b64_tr_b16 v[58:59], v115 offset:15520
  v_mfma_f32_16x16x32_bf16 v[192:195], v[24:27], v[64:67], v[192:195]
  ds_read_b64_tr_b16 v[60:61], v118 offset:1024
  v_mfma_f32_16x16x32_bf16 v[196:199], v[24:27], v[68:71], v[196:199]
  ds_read_b64_tr_b16 v[62:63], v118 offset:1280
  v_mfma_f32_16x16x32_bf16 v[200:203], v[24:27], v[72:75], v[200:203]
  v_mfma_f32_16x16x32_bf16 v[204:207], v[24:27], v[76:79], v[204:207]
  v_mfma_f32_16x16x32_bf16 v[208:211], v[28:31], v[64:67], v[208:211]
  v_mfma_f32_16x16x32_bf16 v[212:215], v[28:31], v[68:71], v[212:215]
  v_mfma_f32_16x16x32_bf16 v[216:219], v[28:31], v[72:75], v[216:219]
  v_mfma_f32_16x16x32_bf16 v[220:223], v[28:31], v[76:79], v[220:223]
  v_mfma_f32_16x16x32_bf16 v[224:227], v[32:35], v[64:67], v[224:227]
  v_mfma_f32_16x16x32_bf16 v[228:231], v[32:35], v[68:71], v[228:231]
  v_mfma_f32_16x16x32_bf16 v[232:235], v[32:35], v[72:75], v[232:235]
  v_mfma_f32_16x16x32_bf16 v[236:239], v[32:35], v[76:79], v[236:239]
  s_add_u32 s58, s58, 45056
  s_cmp_eq_u32 s58, 135168
  s_cselect_b32 s58, 0, s58
  s_waitcnt lgkmcnt(0)
  s_barrier
  v_mfma_f32_16x16x32_bf16 v[128:131], v[36:39], v[80:83], v[128:131]
  v_add_u32 v112, s58, v105
  v_mfma_f32_16x16x32_bf16 v[132:135], v[36:39], v[84:87], v[132:135]
  v_add_u32 v113, s58, v106
  v_mfma_f32_16x16x32_bf16 v[136:139], v[36:39], v[88:91], v[136:139]
  v_add_u32 v114, s58, v107
  v_mfma_f32_16x16x32_bf16 v[140:143], v[36:39], v[92:95], v[140:143]
  v_add_u32 v115, s58, v108
  v_mfma_f32_16x16x32_bf16 v[144:147], v[40:43], v[80:83], v[144:147]
  v_add_u32 v116, s58, v109
  v_mfma_f32_16x16x32_bf16 v[148:151], v[40:43], v[84:87], v[148:151]
  v_add_u32 v117, s58, v110
  v_mfma_f32_16x16x32_bf16 v[152:155], v[40:43], v[88:91], v[152:155]
  v_add_u32 v118, s58, v111
  v_mfma_f32_16x16x32_bf16 v[156:159], v[40:43], v[92:95], v[156:159]
  ds_read_b64_tr_b16 v[8:9], v114 offset:0
  v_mfma_f32_16x16x32_bf16 v[160:163], v[44:47], v[80:83], v[160:163]
  ds_read_b64_tr_b16 v[10:11], v114 offset:3072
  v_mfma_f32_16x16x32_bf16 v[164:167], v[44:47], v[84:87], v[164:167]
  ds_read_b128 v[64:67], v112 offset:0
  v_mfma_f32_16x16x32_bf16 v[168:171], v[44:47], v[88:91], v[168:171]
  ds_read_b128 v[68:71], v112 offset:2048
  v_mfma_f32_16x16x32_bf16 v[172:175], v[44:47], v[92:95], v[172:175]
  ds_read_b128 v[72:75], v112 offset:4096
  v_mfma_f32_16x16x32_bf16 v[176:179], v[48:51], v[80:83], v[176:179]
  ds_read_b128 v[76:79], v112 offset:6144
  v_mfma_f32_16x16x32_bf16 v[180:183], v[48:51], v[84:87], v[180:183]
  ds_read_b64_tr_b16 v[12:13], v115 offset:32
  v_mfma_f32_16x16x32_bf16 v[184:187], v[48:51], v[88:91], v[184:187]
  ds_read_b64_tr_b16 v[14:15], v115 offset:3104
  v_mfma_f32_16x16x32_bf16 v[188:191], v[48:51], v[92:95], v[188:191]
  ds_read_b64_tr_b16 v[16:17], v116 offset:64
  v_mfma_f32_16x16x32_bf16 v[192:195], v[52:55], v[80:83], v[192:195]
  ds_read_b64_tr_b16 v[18:19], v116 offset:3136
  v_mfma_f32_16x16x32_bf16 v[196:199], v[52:55], v[84:87], v[196:199]
  ds_read_b64_tr_b16 v[20:21], v117 offset:96
  v_mfma_f32_16x16x32_bf16 v[200:203], v[52:55], v[88:91], v[200:203]
  ds_read_b64_tr_b16 v[22:23], v117 offset:3168
  v_mfma_f32_16x16x32_bf16 v[204:207], v[52:55], v[92:95], v[204:207]
  ds_read_b64_tr_b16 v[24:25], v114 offset:128
  v_mfma_f32_16x16x32_bf16 v[208:211], v[56:59], v[80:83], v[208:211]
  ds_read_b64_tr_b16 v[26:27], v114 offset:3200
  v_mfma_f32_16x16x32_bf16 v[212:215], v[56:59], v[84:87], v[212:215]
  ds_read_b64_tr_b16 v[28:29], v115 offset:160
  v_mfma_f32_16x16x32_bf16 v[216:219], v[56:59], v[88:91], v[216:219]
  ds_read_b64_tr_b16 v[30:31], v115 offset:3232
  v_mfma_f32_16x16x32_bf16 v[220:223], v[56:59], v[92:95], v[220:223]
  ds_read_b64_tr_b16 v[32:33], v118 offset:0
  v_mfma_f32_16x16x32_bf16 v[224:227], v[60:63], v[80:83], v[224:227]
  ds_read_b64_tr_b16 v[34:35], v118 offset:256
  v_mfma_f32_16x16x32_bf16 v[228:231], v[60:63], v[84:87], v[228:231]
  v_mfma_f32_16x16x32_bf16 v[232:235], v[60:63], v[88:91], v[232:235]
  v_mfma_f32_16x16x32_bf16 v[236:239], v[60:63], v[92:95], v[236:239]
  s_add_u32 s59, s59, 1
  s_cmp_lt_u32 s59, 10
  s_waitcnt lgkmcnt(0)
  s_cbranch_scc1 L_s1_loop_B0
  v_and_b32 v2, 15, v1
  v_lshrrev_b32 v3, 4, v1
  s_lshl_b32 s60, s32, 7
  s_lshl_b32 s63, s52, 6
  s_add_u32 s60, s60, s63
  s_lshl_b32 s63, s52, 8
  v_lshl_add_u32 v6, v2, 2, s63
  s_barrier
  ds_read_b32 v20, v6 offset:0
  ds_read_b32 v22, v6 offset:64
  ds_read_b32 v24, v6 offset:128
  ds_read_b32 v26, v6 offset:192
  s_waitcnt lgkmcnt(0)
  v_and_b32 v4, 1, v3
  v_mul_u32_u24 v4, 192, v4
  v_lshrrev_b32 v5, 1, v3
  v_add_u32 v4, v4, v5
  v_lshlrev_b32 v4, 8, v4
  v_lshl_add_u32 v5, v2, 4, v4
  s_lshr_b32 s63, s60, 4
  s_mul_i32 s63, s63, 192
  s_mul_i32 s64, s33, 24
  s_add_u32 s63, s63, s64
  s_add_u32 s63, s63, 0
  s_lshl_b32 s63, s63, 8
  s_add_u32 s63, s63, 0x1000000
  s_add_u32 s66, s63, 98304
  v_max_f32 v128, 0, v128
  v_max_f32 v129, 0, v129
  v_max_f32 v130, 0, v130
  v_max_f32 v131, 0, v131
  v_max_f32 v132, 0, v132
  v_max_f32 v133, 0, v133
  v_max_f32 v134, 0, v134
  v_max_f32 v135, 0, v135
  v_pk_mul_f32 v[128:129], v[128:129], v[128:129]
  v_pk_mul_f32 v[130:131], v[130:131], v[130:131]
  v_pk_mul_f32 v[132:133], v[132:133], v[132:133]
  v_pk_mul_f32 v[134:135], v[134:135], v[134:135]
  v_pk_mul_f32 v[128:129], v[128:129], v[20:21] op_sel_hi:[1,0]
  v_pk_mul_f32 v[130:131], v[130:131], v[20:21] op_sel_hi:[1,0]
  v_pk_mul_f32 v[132:133], v[132:133], v[22:23] op_sel_hi:[1,0]
  v_pk_mul_f32 v[134:135], v[134:135], v[22:23] op_sel_hi:[1,0]
  v_cvt_pk_bf16_f32 v128, v128, v129
  v_cvt_pk_bf16_f32 v129, v130, v131
  v_cvt_pk_bf16_f32 v130, v132, v133
  v_cvt_pk_bf16_f32 v131, v134, v135
  s_nop 1
  v_permlane16_swap_b32 v128, v130
  v_permlane16_swap_b32 v129, v131
  buffer_store_dwordx4 v[128:131], v5, s[20:23], s63 offen offset:0
  v_max_f32 v136, 0, v136
  v_max_f32 v137, 0, v137
  v_max_f32 v138, 0, v138
  v_max_f32 v139, 0, v139
  v_max_f32 v140, 0, v140
  v_max_f32 v141, 0, v141
  v_max_f32 v142, 0, v142
  v_max_f32 v143, 0, v143
  v_pk_mul_f32 v[136:137], v[136:137], v[136:137]
  v_pk_mul_f32 v[138:139], v[138:139], v[138:139]
  v_pk_mul_f32 v[140:141], v[140:141], v[140:141]
  v_pk_mul_f32 v[142:143], v[142:143], v[142:143]
  v_pk_mul_f32 v[136:137], v[136:137], v[24:25] op_sel_hi:[1,0]
  v_pk_mul_f32 v[138:139], v[138:139], v[24:25] op_sel_hi:[1,0]
  v_pk_mul_f32 v[140:141], v[140:141], v[26:27] op_sel_hi:[1,0]
  v_pk_mul_f32 v[142:143], v[142:143], v[26:27] op_sel_hi:[1,0]
  v_cvt_pk_bf16_f32 v136, v136, v137
  v_cvt_pk_bf16_f32 v137, v138, v139
  v_cvt_pk_bf16_f32 v138, v140, v141
  v_cvt_pk_bf16_f32 v139, v142, v143
  s_nop 1
  v_permlane16_swap_b32 v136, v138
  v_permlane16_swap_b32 v137, v139
  buffer_store_dwordx4 v[136:139], v5, s[20:23], s66 offen offset:0
  v_max_f32 v144, 0, v144
  v_max_f32 v145, 0, v145
  v_max_f32 v146, 0, v146
  v_max_f32 v147, 0, v147
  v_max_f32 v148, 0, v148
  v_max_f32 v149, 0, v149
  v_max_f32 v150, 0, v150
  v_max_f32 v151, 0, v151
  v_pk_mul_f32 v[144:145], v[144:145], v[144:145]
  v_pk_mul_f32 v[146:147], v[146:147], v[146:147]
  v_pk_mul_f32 v[148:149], v[148:149], v[148:149]
  v_pk_mul_f32 v[150:151], v[150:151], v[150:151]
  v_pk_mul_f32 v[144:145], v[144:145], v[20:21] op_sel_hi:[1,0]
  v_pk_mul_f32 v[146:147], v[146:147], v[20:21] op_sel_hi:[1,0]
  v_pk_mul_f32 v[148:149], v[148:149], v[22:23] op_sel_hi:[1,0]
  v_pk_mul_f32 v[150:151], v[150:151], v[22:23] op_sel_hi:[1,0]
  v_cvt_pk_bf16_f32 v144, v144, v145
  v_cvt_pk_bf16_f32 v145, v146, v147
  v_cvt_pk_bf16_f32 v146, v148, v149
  v_cvt_pk_bf16_f32 v147, v150, v151
  s_nop 1
  v_permlane16_swap_b32 v144, v146
  v_permlane16_swap_b32 v145, v147
  buffer_store_dwordx4 v[144:147], v5, s[20:23], s63 offen offset:512
  v_max_f32 v152, 0, v152
  v_max_f32 v153, 0, v153
  v_max_f32 v154, 0, v154
  v_max_f32 v155, 0, v155
  v_max_f32 v156, 0, v156
  v_max_f32 v157, 0, v157
  v_max_f32 v158, 0, v158
  v_max_f32 v159, 0, v159
  v_pk_mul_f32 v[152:153], v[152:153], v[152:153]
  v_pk_mul_f32 v[154:155], v[154:155], v[154:155]
  v_pk_mul_f32 v[156:157], v[156:157], v[156:157]
  v_pk_mul_f32 v[158:159], v[158:159], v[158:159]
  v_pk_mul_f32 v[152:153], v[152:153], v[24:25] op_sel_hi:[1,0]
  v_pk_mul_f32 v[154:155], v[154:155], v[24:25] op_sel_hi:[1,0]
  v_pk_mul_f32 v[156:157], v[156:157], v[26:27] op_sel_hi:[1,0]
  v_pk_mul_f32 v[158:159], v[158:159], v[26:27] op_sel_hi:[1,0]
  v_cvt_pk_bf16_f32 v152, v152, v153
  v_cvt_pk_bf16_f32 v153, v154, v155
  v_cvt_pk_bf16_f32 v154, v156, v157
  v_cvt_pk_bf16_f32 v155, v158, v159
  s_nop 1
  v_permlane16_swap_b32 v152, v154
  v_permlane16_swap_b32 v153, v155
  buffer_store_dwordx4 v[152:155], v5, s[20:23], s66 offen offset:512
  v_max_f32 v160, 0, v160
  v_max_f32 v161, 0, v161
  v_max_f32 v162, 0, v162
  v_max_f32 v163, 0, v163
  v_max_f32 v164, 0, v164
  v_max_f32 v165, 0, v165
  v_max_f32 v166, 0, v166
  v_max_f32 v167, 0, v167
  v_pk_mul_f32 v[160:161], v[160:161], v[160:161]
  v_pk_mul_f32 v[162:163], v[162:163], v[162:163]
  v_pk_mul_f32 v[164:165], v[164:165], v[164:165]
  v_pk_mul_f32 v[166:167], v[166:167], v[166:167]
  v_pk_mul_f32 v[160:161], v[160:161], v[20:21] op_sel_hi:[1,0]
  v_pk_mul_f32 v[162:163], v[162:163], v[20:21] op_sel_hi:[1,0]
  v_pk_mul_f32 v[164:165], v[164:165], v[22:23] op_sel_hi:[1,0]
  v_pk_mul_f32 v[166:167], v[166:167], v[22:23] op_sel_hi:[1,0]
  v_cvt_pk_bf16_f32 v160, v160, v161
  v_cvt_pk_bf16_f32 v161, v162, v163
  v_cvt_pk_bf16_f32 v162, v164, v165
  v_cvt_pk_bf16_f32 v163, v166, v167
  s_nop 1
  v_permlane16_swap_b32 v160, v162
  v_permlane16_swap_b32 v161, v163
  buffer_store_dwordx4 v[160:163], v5, s[20:23], s63 offen offset:1024
  v_max_f32 v168, 0, v168
  v_max_f32 v169, 0, v169
  v_max_f32 v170, 0, v170
  v_max_f32 v171, 0, v171
  v_max_f32 v172, 0, v172
  v_max_f32 v173, 0, v173
  v_max_f32 v174, 0, v174
  v_max_f32 v175, 0, v175
  v_pk_mul_f32 v[168:169], v[168:169], v[168:169]
  v_pk_mul_f32 v[170:171], v[170:171], v[170:171]
  v_pk_mul_f32 v[172:173], v[172:173], v[172:173]
  v_pk_mul_f32 v[174:175], v[174:175], v[174:175]
  v_pk_mul_f32 v[168:169], v[168:169], v[24:25] op_sel_hi:[1,0]
  v_pk_mul_f32 v[170:171], v[170:171], v[24:25] op_sel_hi:[1,0]
  v_pk_mul_f32 v[172:173], v[172:173], v[26:27] op_sel_hi:[1,0]
  v_pk_mul_f32 v[174:175], v[174:175], v[26:27] op_sel_hi:[1,0]
  v_cvt_pk_bf16_f32 v168, v168, v169
  v_cvt_pk_bf16_f32 v169, v170, v171
  v_cvt_pk_bf16_f32 v170, v172, v173
  v_cvt_pk_bf16_f32 v171, v174, v175
  s_nop 1
  v_permlane16_swap_b32 v168, v170
  v_permlane16_swap_b32 v169, v171
  buffer_store_dwordx4 v[168:171], v5, s[20:23], s66 offen offset:1024
  v_max_f32 v176, 0, v176
  v_max_f32 v177, 0, v177
  v_max_f32 v178, 0, v178
  v_max_f32 v179, 0, v179
  v_max_f32 v180, 0, v180
  v_max_f32 v181, 0, v181
  v_max_f32 v182, 0, v182
  v_max_f32 v183, 0, v183
  v_pk_mul_f32 v[176:177], v[176:177], v[176:177]
  v_pk_mul_f32 v[178:179], v[178:179], v[178:179]
  v_pk_mul_f32 v[180:181], v[180:181], v[180:181]
  v_pk_mul_f32 v[182:183], v[182:183], v[182:183]
  v_pk_mul_f32 v[176:177], v[176:177], v[20:21] op_sel_hi:[1,0]
  v_pk_mul_f32 v[178:179], v[178:179], v[20:21] op_sel_hi:[1,0]
  v_pk_mul_f32 v[180:181], v[180:181], v[22:23] op_sel_hi:[1,0]
  v_pk_mul_f32 v[182:183], v[182:183], v[22:23] op_sel_hi:[1,0]
  v_cvt_pk_bf16_f32 v176, v176, v177
  v_cvt_pk_bf16_f32 v177, v178, v179
  v_cvt_pk_bf16_f32 v178, v180, v181
  v_cvt_pk_bf16_f32 v179, v182, v183
  s_nop 1
  v_permlane16_swap_b32 v176, v178
  v_permlane16_swap_b32 v177, v179
  buffer_store_dwordx4 v[176:179], v5, s[20:23], s63 offen offset:1536
  v_max_f32 v184, 0, v184
  v_max_f32 v185, 0, v185
  v_max_f32 v186, 0, v186
  v_max_f32 v187, 0, v187
  v_max_f32 v188, 0, v188
  v_max_f32 v189, 0, v189
  v_max_f32 v190, 0, v190
  v_max_f32 v191, 0, v191
  v_pk_mul_f32 v[184:185], v[184:185], v[184:185]
  v_pk_mul_f32 v[186:187], v[186:187], v[186:187]
  v_pk_mul_f32 v[188:189], v[188:189], v[188:189]
  v_pk_mul_f32 v[190:191], v[190:191], v[190:191]
  v_pk_mul_f32 v[184:185], v[184:185], v[24:25] op_sel_hi:[1,0]
  v_pk_mul_f32 v[186:187], v[186:187], v[24:25] op_sel_hi:[1,0]
  v_pk_mul_f32 v[188:189], v[188:189], v[26:27] op_sel_hi:[1,0]
  v_pk_mul_f32 v[190:191], v[190:191], v[26:27] op_sel_hi:[1,0]
  v_cvt_pk_bf16_f32 v184, v184, v185
  v_cvt_pk_bf16_f32 v185, v186, v187
  v_cvt_pk_bf16_f32 v186, v188, v189
  v_cvt_pk_bf16_f32 v187, v190, v191
  s_nop 1
  v_permlane16_swap_b32 v184, v186
  v_permlane16_swap_b32 v185, v187
  buffer_store_dwordx4 v[184:187], v5, s[20:23], s66 offen offset:1536
  v_max_f32 v192, 0, v192
  v_max_f32 v193, 0, v193
  v_max_f32 v194, 0, v194
  v_max_f32 v195, 0, v195
  v_max_f32 v196, 0, v196
  v_max_f32 v197, 0, v197
  v_max_f32 v198, 0, v198
  v_max_f32 v199, 0, v199
  v_pk_mul_f32 v[192:193], v[192:193], v[192:193]
  v_pk_mul_f32 v[194:195], v[194:195], v[194:195]
  v_pk_mul_f32 v[196:197], v[196:197], v[196:197]
  v_pk_mul_f32 v[198:199], v[198:199], v[198:199]
  v_pk_mul_f32 v[192:193], v[192:193], v[20:21] op_sel_hi:[1,0]
  v_pk_mul_f32 v[194:195], v[194:195], v[20:21] op_sel_hi:[1,0]
  v_pk_mul_f32 v[196:197], v[196:197], v[22:23] op_sel_hi:[1,0]
  v_pk_mul_f32 v[198:199], v[198:199], v[22:23] op_sel_hi:[1,0]
  v_cvt_pk_bf16_f32 v192, v192, v193
  v_cvt_pk_bf16_f32 v193, v194, v195
  v_cvt_pk_bf16_f32 v194, v196, v197
  v_cvt_pk_bf16_f32 v195, v198, v199
  s_nop 1
  v_permlane16_swap_b32 v192, v194
  v_permlane16_swap_b32 v193, v195
  buffer_store_dwordx4 v[192:195], v5, s[20:23], s63 offen offset:2048
  v_max_f32 v200, 0, v200
  v_max_f32 v201, 0, v201
  v_max_f32 v202, 0, v202
  v_max_f32 v203, 0, v203
  v_max_f32 v204, 0, v204
  v_max_f32 v205, 0, v205
  v_max_f32 v206, 0, v206
  v_max_f32 v207, 0, v207
  v_pk_mul_f32 v[200:201], v[200:201], v[200:201]
  v_pk_mul_f32 v[202:203], v[202:203], v[202:203]
  v_pk_mul_f32 v[204:205], v[204:205], v[204:205]
  v_pk_mul_f32 v[206:207], v[206:207], v[206:207]
  v_pk_mul_f32 v[200:201], v[200:201], v[24:25] op_sel_hi:[1,0]
  v_pk_mul_f32 v[202:203], v[202:203], v[24:25] op_sel_hi:[1,0]
  v_pk_mul_f32 v[204:205], v[204:205], v[26:27] op_sel_hi:[1,0]
  v_pk_mul_f32 v[206:207], v[206:207], v[26:27] op_sel_hi:[1,0]
  v_cvt_pk_bf16_f32 v200, v200, v201
  v_cvt_pk_bf16_f32 v201, v202, v203
  v_cvt_pk_bf16_f32 v202, v204, v205
  v_cvt_pk_bf16_f32 v203, v206, v207
  s_nop 1
  v_permlane16_swap_b32 v200, v202
  v_permlane16_swap_b32 v201, v203
  buffer_store_dwordx4 v[200:203], v5, s[20:23], s66 offen offset:2048
  v_max_f32 v208, 0, v208
  v_max_f32 v209, 0, v209
  v_max_f32 v210, 0, v210
  v_max_f32 v211, 0, v211
  v_max_f32 v212, 0, v212
  v_max_f32 v213, 0, v213
  v_max_f32 v214, 0, v214
  v_max_f32 v215, 0, v215
  v_pk_mul_f32 v[208:209], v[208:209], v[208:209]
  v_pk_mul_f32 v[210:211], v[210:211], v[210:211]
  v_pk_mul_f32 v[212:213], v[212:213], v[212:213]
  v_pk_mul_f32 v[214:215], v[214:215], v[214:215]
  v_pk_mul_f32 v[208:209], v[208:209], v[20:21] op_sel_hi:[1,0]
  v_pk_mul_f32 v[210:211], v[210:211], v[20:21] op_sel_hi:[1,0]
  v_pk_mul_f32 v[212:213], v[212:213], v[22:23] op_sel_hi:[1,0]
  v_pk_mul_f32 v[214:215], v[214:215], v[22:23] op_sel_hi:[1,0]
  v_cvt_pk_bf16_f32 v208, v208, v209
  v_cvt_pk_bf16_f32 v209, v210, v211
  v_cvt_pk_bf16_f32 v210, v212, v213
  v_cvt_pk_bf16_f32 v211, v214, v215
  s_nop 1
  v_permlane16_swap_b32 v208, v210
  v_permlane16_swap_b32 v209, v211
  buffer_store_dwordx4 v[208:211], v5, s[20:23], s63 offen offset:2560
  v_max_f32 v216, 0, v216
  v_max_f32 v217, 0, v217
  v_max_f32 v218, 0, v218
  v_max_f32 v219, 0, v219
  v_max_f32 v220, 0, v220
  v_max_f32 v221, 0, v221
  v_max_f32 v222, 0, v222
  v_max_f32 v223, 0, v223
  v_pk_mul_f32 v[216:217], v[216:217], v[216:217]
  v_pk_mul_f32 v[218:219], v[218:219], v[218:219]
  v_pk_mul_f32 v[220:221], v[220:221], v[220:221]
  v_pk_mul_f32 v[222:223], v[222:223], v[222:223]
  v_pk_mul_f32 v[216:217], v[216:217], v[24:25] op_sel_hi:[1,0]
  v_pk_mul_f32 v[218:219], v[218:219], v[24:25] op_sel_hi:[1,0]
  v_pk_mul_f32 v[220:221], v[220:221], v[26:27] op_sel_hi:[1,0]
  v_pk_mul_f32 v[222:223], v[222:223], v[26:27] op_sel_hi:[1,0]
  v_cvt_pk_bf16_f32 v216, v216, v217
  v_cvt_pk_bf16_f32 v217, v218, v219
  v_cvt_pk_bf16_f32 v218, v220, v221
  v_cvt_pk_bf16_f32 v219, v222, v223
  s_nop 1
  v_permlane16_swap_b32 v216, v218
  v_permlane16_swap_b32 v217, v219
  buffer_store_dwordx4 v[216:219], v5, s[20:23], s66 offen offset:2560
  s_lshl_b32 s63, s33, 2
  s_add_u32 s63, s63, 128
  s_lshr_b32 s64, s60, 4
  s_mul_i32 s64, s64, 160
  s_add_u32 s63, s63, s64
  s_lshl_b32 s63, s63, 7
  s_add_u32 s63, s63, 0x600000
  v_lshlrev_b32 v7, 3, v1
  v_pk_mul_f32 v[96:97], v[224:225], s[78:79]
  v_pk_mul_f32 v[98:99], v[226:227], s[78:79]
  v_pk_mul_f32 v[100:101], v[228:229], s[78:79]
  v_pk_mul_f32 v[102:103], v[230:231], s[78:79]
  v_pk_mul_f32 v[104:105], v[232:233], s[78:79]
  v_pk_mul_f32 v[106:107], v[234:235], s[78:79]
  v_pk_mul_f32 v[108:109], v[236:237], s[78:79]
  v_pk_mul_f32 v[110:111], v[238:239], s[78:79]
  v_exp_f32_e64 v96, v96 clamp
  v_max_f32 v224, s80, v224
  v_exp_f32_e64 v97, v97 clamp
  v_max_f32 v225, s80, v225
  v_exp_f32_e64 v98, v98 clamp
  v_max_f32 v226, s80, v226
  v_exp_f32_e64 v99, v99 clamp
  v_max_f32 v227, s80, v227
  v_exp_f32_e64 v100, v100 clamp
  v_max_f32 v228, s80, v228
  v_exp_f32_e64 v101, v101 clamp
  v_max_f32 v229, s80, v229
  v_exp_f32_e64 v102, v102 clamp
  v_max_f32 v230, s80, v230
  v_exp_f32_e64 v103, v103 clamp
  v_max_f32 v231, s80, v231
  v_exp_f32_e64 v104, v104 clamp
  v_max_f32 v232, s80, v232
  v_exp_f32_e64 v105, v105 clamp
  v_max_f32 v233, s80, v233
  v_exp_f32_e64 v106, v106 clamp
  v_max_f32 v234, s80, v234
  v_exp_f32_e64 v107, v107 clamp
  v_max_f32 v235, s80, v235
  v_exp_f32_e64 v108, v108 clamp
  v_max_f32 v236, s80, v236
  v_exp_f32_e64 v109, v109 clamp
  v_max_f32 v237, s80, v237
  v_exp_f32_e64 v110, v110 clamp
  v_max_f32 v238, s80, v238
  v_exp_f32_e64 v111, v111 clamp
  v_max_f32 v239, s80, v239
  v_pk_add_f32 v[224:225], v[224:225], v[96:97]
  v_pk_add_f32 v[226:227], v[226:227], v[98:99]
  v_pk_add_f32 v[228:229], v[228:229], v[100:101]
  v_pk_add_f32 v[230:231], v[230:231], v[102:103]
  v_pk_add_f32 v[232:233], v[232:233], v[104:105]
  v_pk_add_f32 v[234:235], v[234:235], v[106:107]
  v_pk_add_f32 v[236:237], v[236:237], v[108:109]
  v_pk_add_f32 v[238:239], v[238:239], v[110:111]
  v_cvt_pk_bf16_f32 v224, v224, v225
  v_cvt_pk_bf16_f32 v225, v226, v227
  s_add_u32 s64, s63, 0
  buffer_store_dwordx2 v[224:225], v7, s[20:23], s64 offen
  v_cvt_pk_bf16_f32 v228, v228, v229
  v_cvt_pk_bf16_f32 v229, v230, v231
  s_add_u32 s64, s63, 20480
  buffer_store_dwordx2 v[228:229], v7, s[20:23], s64 offen
  v_cvt_pk_bf16_f32 v232, v232, v233
  v_cvt_pk_bf16_f32 v233, v234, v235
  s_add_u32 s64, s63, 40960
  buffer_store_dwordx2 v[232:233], v7, s[20:23], s64 offen
  v_cvt_pk_bf16_f32 v236, v236, v237
  v_cvt_pk_bf16_f32 v237, v238, v239
  s_add_u32 s64, s63, 61440
  buffer_store_dwordx2 v[236:237], v7, s[20:23], s64 offen
  s_endpgm
L_s1_B1:
  s_waitcnt vmcnt(8)
  v_lshlrev_b32 v128, 16, v32
  v_and_b32 v129, 0xffff0000, v32
  v_lshlrev_b32 v130, 16, v33
  v_and_b32 v131, 0xffff0000, v33
  v_pk_mov_b32 v[132:133], v[128:129], v[128:129] op_sel:[0,1]
  v_pk_mov_b32 v[134:135], v[130:131], v[130:131] op_sel:[0,1]
  v_pk_mov_b32 v[136:137], v[128:129], v[128:129] op_sel:[0,1]
  v_pk_mov_b32 v[138:139], v[130:131], v[130:131] op_sel:[0,1]
  v_pk_mov_b32 v[140:141], v[128:129], v[128:129] op_sel:[0,1]
  v_pk_mov_b32 v[142:143], v[130:131], v[130:131] op_sel:[0,1]
  v_lshlrev_b32 v144, 16, v34
  v_and_b32 v145, 0xffff0000, v34
  v_lshlrev_b32 v146, 16, v35
  v_and_b32 v147, 0xffff0000, v35
  v_pk_mov_b32 v[148:149], v[144:145], v[144:145] op_sel:[0,1]
  v_pk_mov_b32 v[150:151], v[146:147], v[146:147] op_sel:[0,1]
  v_pk_mov_b32 v[152:153], v[144:145], v[144:145] op_sel:[0,1]
  v_pk_mov_b32 v[154:155], v[146:147], v[146:147] op_sel:[0,1]
  v_pk_mov_b32 v[156:157], v[144:145], v[144:145] op_sel:[0,1]
  v_pk_mov_b32 v[158:159], v[146:147], v[146:147] op_sel:[0,1]
  v_lshlrev_b32 v160, 16, v36
  v_and_b32 v161, 0xffff0000, v36
  v_lshlrev_b32 v162, 16, v37
  v_and_b32 v163, 0xffff0000, v37
  v_pk_mov_b32 v[164:165], v[160:161], v[160:161] op_sel:[0,1]
  v_pk_mov_b32 v[166:167], v[162:163], v[162:163] op_sel:[0,1]
  v_pk_mov_b32 v[168:169], v[160:161], v[160:161] op_sel:[0,1]
  v_pk_mov_b32 v[170:171], v[162:163], v[162:163] op_sel:[0,1]
  v_pk_mov_b32 v[172:173], v[160:161], v[160:161] op_sel:[0,1]
  v_pk_mov_b32 v[174:175], v[162:163], v[162:163] op_sel:[0,1]
  v_lshlrev_b32 v176, 16, v38
  v_and_b32 v177, 0xffff0000, v38
  v_lshlrev_b32 v178, 16, v39
  v_and_b32 v179, 0xffff0000, v39
  v_pk_mov_b32 v[180:181], v[176:177], v[176:177] op_sel:[0,1]
  v_pk_mov_b32 v[182:183], v[178:179], v[178:179] op_sel:[0,1]
  v_pk_mov_b32 v[184:185], v[176:177], v[176:177] op_sel:[0,1]
  v_pk_mov_b32 v[186:187], v[178:179], v[178:179] op_sel:[0,1]
  v_pk_mov_b32 v[188:189], v[176:177], v[176:177] op_sel:[0,1]
  v_pk_mov_b32 v[190:191], v[178:179], v[178:179] op_sel:[0,1]
  v_lshlrev_b32 v192, 16, v40
  v_and_b32 v193, 0xffff0000, v40
  v_lshlrev_b32 v194, 16, v41
  v_and_b32 v195, 0xffff0000, v41
  v_pk_mov_b32 v[196:197], v[192:193], v[192:193] op_sel:[0,1]
  v_pk_mov_b32 v[198:199], v[194:195], v[194:195] op_sel:[0,1]
  v_pk_mov_b32 v[200:201], v[192:193], v[192:193] op_sel:[0,1]
  v_pk_mov_b32 v[202:203], v[194:195], v[194:195] op_sel:[0,1]
  v_pk_mov_b32 v[204:205], v[192:193], v[192:193] op_sel:[0,1]
  v_pk_mov_b32 v[206:207], v[194:195], v[194:195] op_sel:[0,1]
  v_lshlrev_b32 v208, 16, v42
  v_and_b32 v209, 0xffff0000, v42
  v_lshlrev_b32 v210, 16, v43
  v_and_b32 v211, 0xffff0000, v43
  v_pk_mov_b32 v[212:213], v[208:209], v[208:209] op_sel:[0,1]
  v_pk_mov_b32 v[214:215], v[210:211], v[210:211] op_sel:[0,1]
  v_pk_mov_b32 v[216:217], v[208:209], v[208:209] op_sel:[0,1]
  v_pk_mov_b32 v[218:219], v[210:211], v[210:211] op_sel:[0,1]
  v_pk_mov_b32 v[220:221], v[208:209], v[208:209] op_sel:[0,1]
  v_pk_mov_b32 v[222:223], v[210:211], v[210:211] op_sel:[0,1]
  v_pk_mov_b32 v[224:225], 0, 0
  v_pk_mov_b32 v[226:227], 0, 0
  v_pk_mov_b32 v[228:229], 0, 0
  v_pk_mov_b32 v[230:231], 0, 0
  v_pk_mov_b32 v[232:233], 0, 0
  v_pk_mov_b32 v[234:235], 0, 0
  v_pk_mov_b32 v[236:237], 0, 0
  v_pk_mov_b32 v[238:239], 0, 0
  v_add_u32 v112, s58, v105
  v_add_u32 v113, s58, v106
  v_add_u32 v114, s58, v107
  v_add_u32 v115, s58, v108
  v_add_u32 v116, s58, v109
  v_add_u32 v117, s58, v110
  v_add_u32 v118, s58, v111
  v_lshrrev_b32 v119, 4, v1
  v_lshlrev_b32 v119, 4, v119
  v_add_u32 v119, 147456, v119
  s_barrier
  ds_read_b64_tr_b16 v[8:9], v116 offset:192
  ds_read_b64_tr_b16 v[10:11], v116 offset:3264
  ds_read_b128 v[64:67], v112 offset:0
  ds_read_b128 v[68:71], v112 offset:2048
  ds_read_b128 v[72:75], v112 offset:4096
  ds_read_b128 v[76:79], v112 offset:6144
  ds_read_b64_tr_b16 v[12:13], v117 offset:224
  ds_read_b64_tr_b16 v[14:15], v117 offset:3296
  ds_read_b64_tr_b16 v[16:17], v114 offset:256
  ds_read_b64_tr_b16 v[18:19], v114 offset:3328
  ds_read_b64_tr_b16 v[20:21], v115 offset:288
  ds_read_b64_tr_b16 v[22:23], v115 offset:3360
  ds_read_b64_tr_b16 v[24:25], v116 offset:320
  ds_read_b64_tr_b16 v[26:27], v116 offset:3392
  ds_read_b64_tr_b16 v[28:29], v117 offset:352
  ds_read_b64_tr_b16 v[30:31], v117 offset:3424
  ds_read_b128 v[32:35], v119 offset:0
  s_waitcnt lgkmcnt(0)
L_s1_loop_B1:
  v_mfma_f32_16x16x32_bf16 v[128:131], v[8:11], v[64:67], v[128:131]
  ds_read_b64_tr_b16 v[36:37], v116 offset:12480
  v_mfma_f32_16x16x32_bf16 v[132:135], v[8:11], v[68:71], v[132:135]
  ds_read_b64_tr_b16 v[38:39], v116 offset:15552
  v_mfma_f32_16x16x32_bf16 v[136:139], v[8:11], v[72:75], v[136:139]
  ds_read_b128 v[80:83], v113 offset:0
  v_mfma_f32_16x16x32_bf16 v[140:143], v[8:11], v[76:79], v[140:143]
  ds_read_b128 v[84:87], v113 offset:2048
  v_mfma_f32_16x16x32_bf16 v[144:147], v[12:15], v[64:67], v[144:147]
  ds_read_b128 v[88:91], v113 offset:4096
  v_mfma_f32_16x16x32_bf16 v[148:151], v[12:15], v[68:71], v[148:151]
  ds_read_b128 v[92:95], v113 offset:6144
  v_mfma_f32_16x16x32_bf16 v[152:155], v[12:15], v[72:75], v[152:155]
  ds_read_b64_tr_b16 v[40:41], v117 offset:12512
  v_mfma_f32_16x16x32_bf16 v[156:159], v[12:15], v[76:79], v[156:159]
  ds_read_b64_tr_b16 v[42:43], v117 offset:15584
  v_mfma_f32_16x16x32_bf16 v[160:163], v[16:19], v[64:67], v[160:163]
  ds_read_b64_tr_b16 v[44:45], v114 offset:12544
  v_mfma_f32_16x16x32_bf16 v[164:167], v[16:19], v[68:71], v[164:167]
  ds_read_b64_tr_b16 v[46:47], v114 offset:15616
  v_mfma_f32_16x16x32_bf16 v[168:171], v[16:19], v[72:75], v[168:171]
  ds_read_b64_tr_b16 v[48:49], v115 offset:12576
  v_mfma_f32_16x16x32_bf16 v[172:175], v[16:19], v[76:79], v[172:175]
  ds_read_b64_tr_b16 v[50:51], v115 offset:15648
  v_mfma_f32_16x16x32_bf16 v[176:179], v[20:23], v[64:67], v[176:179]
  ds_read_b64_tr_b16 v[52:53], v116 offset:12608
  v_mfma_f32_16x16x32_bf16 v[180:183], v[20:23], v[68:71], v[180:183]
  ds_read_b64_tr_b16 v[54:55], v116 offset:15680
  v_mfma_f32_16x16x32_bf16 v[184:187], v[20:23], v[72:75], v[184:187]
  ds_read_b64_tr_b16 v[56:57], v117 offset:12640
  v_mfma_f32_16x16x32_bf16 v[188:191], v[20:23], v[76:79], v[188:191]
  ds_read_b64_tr_b16 v[58:59], v117 offset:15712
  v_mfma_f32_16x16x32_bf16 v[192:195], v[24:27], v[64:67], v[192:195]
  ds_read_b128 v[60:63], v119 offset:64
  v_mfma_f32_16x16x32_bf16 v[196:199], v[24:27], v[68:71], v[196:199]
  v_mfma_f32_16x16x32_bf16 v[200:203], v[24:27], v[72:75], v[200:203]
  v_mfma_f32_16x16x32_bf16 v[204:207], v[24:27], v[76:79], v[204:207]
  v_mfma_f32_16x16x32_bf16 v[208:211], v[28:31], v[64:67], v[208:211]
  v_mfma_f32_16x16x32_bf16 v[212:215], v[28:31], v[68:71], v[212:215]
  v_mfma_f32_16x16x32_bf16 v[216:219], v[28:31], v[72:75], v[216:219]
  v_mfma_f32_16x16x32_bf16 v[220:223], v[28:31], v[76:79], v[220:223]
  v_mfma_f32_16x16x32_bf16 v[224:227], v[32:35], v[64:67], v[224:227]
  v_mfma_f32_16x16x32_bf16 v[228:231], v[32:35], v[68:71], v[228:231]
  v_mfma_f32_16x16x32_bf16 v[232:235], v[32:35], v[72:75], v[232:235]
  v_mfma_f32_16x16x32_bf16 v[236:239], v[32:35], v[76:79], v[236:239]
  s_add_u32 s58, s58, 45056
  s_cmp_eq_u32 s58, 135168
  s_cselect_b32 s58, 0, s58
  s_waitcnt lgkmcnt(0)
  s_barrier
  v_mfma_f32_16x16x32_bf16 v[128:131], v[36:39], v[80:83], v[128:131]
  v_add_u32 v112, s58, v105
  v_mfma_f32_16x16x32_bf16 v[132:135], v[36:39], v[84:87], v[132:135]
  v_add_u32 v113, s58, v106
  v_mfma_f32_16x16x32_bf16 v[136:139], v[36:39], v[88:91], v[136:139]
  v_add_u32 v114, s58, v107
  v_mfma_f32_16x16x32_bf16 v[140:143], v[36:39], v[92:95], v[140:143]
  v_add_u32 v115, s58, v108
  v_mfma_f32_16x16x32_bf16 v[144:147], v[40:43], v[80:83], v[144:147]
  v_add_u32 v116, s58, v109
  v_mfma_f32_16x16x32_bf16 v[148:151], v[40:43], v[84:87], v[148:151]
  v_add_u32 v117, s58, v110
  v_mfma_f32_16x16x32_bf16 v[152:155], v[40:43], v[88:91], v[152:155]
  v_add_u32 v118, s58, v111
  v_mfma_f32_16x16x32_bf16 v[156:159], v[40:43], v[92:95], v[156:159]
  v_add_u32 v119, 128, v119
  v_mfma_f32_16x16x32_bf16 v[160:163], v[44:47], v[80:83], v[160:163]
  ds_read_b64_tr_b16 v[8:9], v116 offset:192
  v_mfma_f32_16x16x32_bf16 v[164:167], v[44:47], v[84:87], v[164:167]
  ds_read_b64_tr_b16 v[10:11], v116 offset:3264
  v_mfma_f32_16x16x32_bf16 v[168:171], v[44:47], v[88:91], v[168:171]
  ds_read_b128 v[64:67], v112 offset:0
  v_mfma_f32_16x16x32_bf16 v[172:175], v[44:47], v[92:95], v[172:175]
  ds_read_b128 v[68:71], v112 offset:2048
  v_mfma_f32_16x16x32_bf16 v[176:179], v[48:51], v[80:83], v[176:179]
  ds_read_b128 v[72:75], v112 offset:4096
  v_mfma_f32_16x16x32_bf16 v[180:183], v[48:51], v[84:87], v[180:183]
  ds_read_b128 v[76:79], v112 offset:6144
  v_mfma_f32_16x16x32_bf16 v[184:187], v[48:51], v[88:91], v[184:187]
  ds_read_b64_tr_b16 v[12:13], v117 offset:224
  v_mfma_f32_16x16x32_bf16 v[188:191], v[48:51], v[92:95], v[188:191]
  ds_read_b64_tr_b16 v[14:15], v117 offset:3296
  v_mfma_f32_16x16x32_bf16 v[192:195], v[52:55], v[80:83], v[192:195]
  ds_read_b64_tr_b16 v[16:17], v114 offset:256
  v_mfma_f32_16x16x32_bf16 v[196:199], v[52:55], v[84:87], v[196:199]
  ds_read_b64_tr_b16 v[18:19], v114 offset:3328
  v_mfma_f32_16x16x32_bf16 v[200:203], v[52:55], v[88:91], v[200:203]
  ds_read_b64_tr_b16 v[20:21], v115 offset:288
  v_mfma_f32_16x16x32_bf16 v[204:207], v[52:55], v[92:95], v[204:207]
  ds_read_b64_tr_b16 v[22:23], v115 offset:3360
  v_mfma_f32_16x16x32_bf16 v[208:211], v[56:59], v[80:83], v[208:211]
  ds_read_b64_tr_b16 v[24:25], v116 offset:320
  v_mfma_f32_16x16x32_bf16 v[212:215], v[56:59], v[84:87], v[212:215]
  ds_read_b64_tr_b16 v[26:27], v116 offset:3392
  v_mfma_f32_16x16x32_bf16 v[216:219], v[56:59], v[88:91], v[216:219]
  ds_read_b64_tr_b16 v[28:29], v117 offset:352
  v_mfma_f32_16x16x32_bf16 v[220:223], v[56:59], v[92:95], v[220:223]
  ds_read_b64_tr_b16 v[30:31], v117 offset:3424
  v_mfma_f32_16x16x32_bf16 v[224:227], v[60:63], v[80:83], v[224:227]
  ds_read_b128 v[32:35], v119 offset:0
  v_mfma_f32_16x16x32_bf16 v[228:231], v[60:63], v[84:87], v[228:231]
  v_mfma_f32_16x16x32_bf16 v[232:235], v[60:63], v[88:91], v[232:235]
  v_mfma_f32_16x16x32_bf16 v[236:239], v[60:63], v[92:95], v[236:239]
  s_add_u32 s59, s59, 1
  s_cmp_lt_u32 s59, 10
  s_waitcnt lgkmcnt(0)
  s_cbranch_scc1 L_s1_loop_B1
  v_and_b32 v2, 15, v1
  v_lshrrev_b32 v3, 4, v1
  s_lshl_b32 s60, s32, 7
  s_lshl_b32 s63, s52, 6
  s_add_u32 s60, s60, s63
  s_lshl_b32 s63, s52, 8
  v_lshl_add_u32 v6, v2, 2, s63
  s_nop 4
  v_cvt_pk_bf16_f32 v21, v224, v224
  v_cvt_pk_bf16_f32 v23, v228, v228
  v_cvt_pk_bf16_f32 v25, v232, v232
  v_cvt_pk_bf16_f32 v27, v236, v236
  v_lshlrev_b32 v21, 16, v21
  v_lshlrev_b32 v23, 16, v23
  v_lshlrev_b32 v25, 16, v25
  v_lshlrev_b32 v27, 16, v27
  v_mul_f32 v21, 0xbfb8aa3b, v21
  v_mul_f32 v23, 0xbfb8aa3b, v23
  v_mul_f32 v25, 0xbfb8aa3b, v25
  v_mul_f32 v27, 0xbfb8aa3b, v27
  v_exp_f32 v21, v21
  v_exp_f32 v23, v23
  v_exp_f32 v25, v25
  v_exp_f32 v27, v27
  s_nop 0
  v_add_f32 v21, 1.0, v21
  v_add_f32 v23, 1.0, v23
  v_add_f32 v25, 1.0, v25
  v_add_f32 v27, 1.0, v27
  v_rcp_f32 v21, v21
  v_rcp_f32 v23, v23
  v_rcp_f32 v25, v25
  v_rcp_f32 v27, v27
  s_nop 0
  v_cvt_pk_bf16_f32 v21, v21, v21
  v_cvt_pk_bf16_f32 v23, v23, v23
  v_cvt_pk_bf16_f32 v25, v25, v25
  v_cvt_pk_bf16_f32 v27, v27, v27
  v_lshlrev_b32 v21, 16, v21
  v_lshlrev_b32 v23, 16, v23
  v_lshlrev_b32 v25, 16, v25
  v_lshlrev_b32 v27, 16, v27
  v_sub_f32 v20, 1.0, v21
  v_sub_f32 v22, 1.0, v23
  v_sub_f32 v24, 1.0, v25
  v_sub_f32 v26, 1.0, v27
  v_cvt_pk_bf16_f32 v20, v20, v20
  v_cvt_pk_bf16_f32 v22, v22, v22
  v_cvt_pk_bf16_f32 v24, v24, v24
  v_cvt_pk_bf16_f32 v26, v26, v26
  v_lshlrev_b32 v20, 16, v20
  v_lshlrev_b32 v22, 16, v22
  v_lshlrev_b32 v24, 16, v24
  v_lshlrev_b32 v26, 16, v26
  v_add_u32 v4, s60, v2
  v_lshlrev_b32 v4, 2, v4
  v_add_u32 v4, 0xa10000, v4
  v_cmp_eq_u32 vcc, 0, v3
  s_and_saveexec_b64 s[72:73], vcc
  ds_write_b32 v6, v20 offset:0
  buffer_store_dword v21, v4, s[20:23], 0 offen offset:0
  ds_write_b32 v6, v22 offset:64
  buffer_store_dword v23, v4, s[20:23], 0 offen offset:64
  ds_write_b32 v6, v24 offset:128
  buffer_store_dword v25, v4, s[20:23], 0 offen offset:128
  ds_write_b32 v6, v26 offset:192
  buffer_store_dword v27, v4, s[20:23], 0 offen offset:192
  s_mov_b64 exec, s[72:73]
  s_waitcnt lgkmcnt(0)
  s_barrier
  v_and_b32 v4, 1, v3
  v_mul_u32_u24 v4, 192, v4
  v_lshrrev_b32 v5, 1, v3
  v_add_u32 v4, v4, v5
  v_lshlrev_b32 v4, 8, v4
  v_lshl_add_u32 v5, v2, 4, v4
  s_lshr_b32 s63, s60, 4
  s_mul_i32 s63, s63, 192
  s_mul_i32 s64, s33, 24
  s_add_u32 s63, s63, s64
  s_add_u32 s63, s63, 12
  s_lshl_b32 s63, s63, 8
  s_add_u32 s63, s63, 0x1000000
  s_add_u32 s66, s63, 98304
  v_max_f32 v128, 0, v128
  v_max_f32 v129, 0, v129
  v_max_f32 v130, 0, v130
  v_max_f32 v131, 0, v131
  v_max_f32 v132, 0, v132
  v_max_f32 v133, 0, v133
  v_max_f32 v134, 0, v134
  v_max_f32 v135, 0, v135
  v_pk_mul_f32 v[128:129], v[128:129], v[128:129]
  v_pk_mul_f32 v[130:131], v[130:131], v[130:131]
  v_pk_mul_f32 v[132:133], v[132:133], v[132:133]
  v_pk_mul_f32 v[134:135], v[134:135], v[134:135]
  v_pk_mul_f32 v[128:129], v[128:129], v[20:21] op_sel_hi:[1,0]
  v_pk_mul_f32 v[130:131], v[130:131], v[20:21] op_sel_hi:[1,0]
  v_pk_mul_f32 v[132:133], v[132:133], v[22:23] op_sel_hi:[1,0]
  v_pk_mul_f32 v[134:135], v[134:135], v[22:23] op_sel_hi:[1,0]
  v_cvt_pk_bf16_f32 v128, v128, v129
  v_cvt_pk_bf16_f32 v129, v130, v131
  v_cvt_pk_bf16_f32 v130, v132, v133
  v_cvt_pk_bf16_f32 v131, v134, v135
  s_nop 1
  v_permlane16_swap_b32 v128, v130
  v_permlane16_swap_b32 v129, v131
  buffer_store_dwordx4 v[128:131], v5, s[20:23], s63 offen offset:0
  v_max_f32 v136, 0, v136
  v_max_f32 v137, 0, v137
  v_max_f32 v138, 0, v138
  v_max_f32 v139, 0, v139
  v_max_f32 v140, 0, v140
  v_max_f32 v141, 0, v141
  v_max_f32 v142, 0, v142
  v_max_f32 v143, 0, v143
  v_pk_mul_f32 v[136:137], v[136:137], v[136:137]
  v_pk_mul_f32 v[138:139], v[138:139], v[138:139]
  v_pk_mul_f32 v[140:141], v[140:141], v[140:141]
  v_pk_mul_f32 v[142:143], v[142:143], v[142:143]
  v_pk_mul_f32 v[136:137], v[136:137], v[24:25] op_sel_hi:[1,0]
  v_pk_mul_f32 v[138:139], v[138:139], v[24:25] op_sel_hi:[1,0]
  v_pk_mul_f32 v[140:141], v[140:141], v[26:27] op_sel_hi:[1,0]
  v_pk_mul_f32 v[142:143], v[142:143], v[26:27] op_sel_hi:[1,0]
  v_cvt_pk_bf16_f32 v136, v136, v137
  v_cvt_pk_bf16_f32 v137, v138, v139
  v_cvt_pk_bf16_f32 v138, v140, v141
  v_cvt_pk_bf16_f32 v139, v142, v143
  s_nop 1
  v_permlane16_swap_b32 v136, v138
  v_permlane16_swap_b32 v137, v139
  buffer_store_dwordx4 v[136:139], v5, s[20:23], s66 offen offset:0
  v_max_f32 v144, 0, v144
  v_max_f32 v145, 0, v145
  v_max_f32 v146, 0, v146
  v_max_f32 v147, 0, v147
  v_max_f32 v148, 0, v148
  v_max_f32 v149, 0, v149
  v_max_f32 v150, 0, v150
  v_max_f32 v151, 0, v151
  v_pk_mul_f32 v[144:145], v[144:145], v[144:145]
  v_pk_mul_f32 v[146:147], v[146:147], v[146:147]
  v_pk_mul_f32 v[148:149], v[148:149], v[148:149]
  v_pk_mul_f32 v[150:151], v[150:151], v[150:151]
  v_pk_mul_f32 v[144:145], v[144:145], v[20:21] op_sel_hi:[1,0]
  v_pk_mul_f32 v[146:147], v[146:147], v[20:21] op_sel_hi:[1,0]
  v_pk_mul_f32 v[148:149], v[148:149], v[22:23] op_sel_hi:[1,0]
  v_pk_mul_f32 v[150:151], v[150:151], v[22:23] op_sel_hi:[1,0]
  v_cvt_pk_bf16_f32 v144, v144, v145
  v_cvt_pk_bf16_f32 v145, v146, v147
  v_cvt_pk_bf16_f32 v146, v148, v149
  v_cvt_pk_bf16_f32 v147, v150, v151
  s_nop 1
  v_permlane16_swap_b32 v144, v146
  v_permlane16_swap_b32 v145, v147
  buffer_store_dwordx4 v[144:147], v5, s[20:23], s63 offen offset:512
  v_max_f32 v152, 0, v152
  v_max_f32 v153, 0, v153
  v_max_f32 v154, 0, v154
  v_max_f32 v155, 0, v155
  v_max_f32 v156, 0, v156
  v_max_f32 v157, 0, v157
  v_max_f32 v158, 0, v158
  v_max_f32 v159, 0, v159
  v_pk_mul_f32 v[152:153], v[152:153], v[152:153]
  v_pk_mul_f32 v[154:155], v[154:155], v[154:155]
  v_pk_mul_f32 v[156:157], v[156:157], v[156:157]
  v_pk_mul_f32 v[158:159], v[158:159], v[158:159]
  v_pk_mul_f32 v[152:153], v[152:153], v[24:25] op_sel_hi:[1,0]
  v_pk_mul_f32 v[154:155], v[154:155], v[24:25] op_sel_hi:[1,0]
  v_pk_mul_f32 v[156:157], v[156:157], v[26:27] op_sel_hi:[1,0]
  v_pk_mul_f32 v[158:159], v[158:159], v[26:27] op_sel_hi:[1,0]
  v_cvt_pk_bf16_f32 v152, v152, v153
  v_cvt_pk_bf16_f32 v153, v154, v155
  v_cvt_pk_bf16_f32 v154, v156, v157
  v_cvt_pk_bf16_f32 v155, v158, v159
  s_nop 1
  v_permlane16_swap_b32 v152, v154
  v_permlane16_swap_b32 v153, v155
  buffer_store_dwordx4 v[152:155], v5, s[20:23], s66 offen offset:512
  v_max_f32 v160, 0, v160
  v_max_f32 v161, 0, v161
  v_max_f32 v162, 0, v162
  v_max_f32 v163, 0, v163
  v_max_f32 v164, 0, v164
  v_max_f32 v165, 0, v165
  v_max_f32 v166, 0, v166
  v_max_f32 v167, 0, v167
  v_pk_mul_f32 v[160:161], v[160:161], v[160:161]
  v_pk_mul_f32 v[162:163], v[162:163], v[162:163]
  v_pk_mul_f32 v[164:165], v[164:165], v[164:165]
  v_pk_mul_f32 v[166:167], v[166:167], v[166:167]
  v_pk_mul_f32 v[160:161], v[160:161], v[20:21] op_sel_hi:[1,0]
  v_pk_mul_f32 v[162:163], v[162:163], v[20:21] op_sel_hi:[1,0]
  v_pk_mul_f32 v[164:165], v[164:165], v[22:23] op_sel_hi:[1,0]
  v_pk_mul_f32 v[166:167], v[166:167], v[22:23] op_sel_hi:[1,0]
  v_cvt_pk_bf16_f32 v160, v160, v161
  v_cvt_pk_bf16_f32 v161, v162, v163
  v_cvt_pk_bf16_f32 v162, v164, v165
  v_cvt_pk_bf16_f32 v163, v166, v167
  s_nop 1
  v_permlane16_swap_b32 v160, v162
  v_permlane16_swap_b32 v161, v163
  buffer_store_dwordx4 v[160:163], v5, s[20:23], s63 offen offset:1024
  v_max_f32 v168, 0, v168
  v_max_f32 v169, 0, v169
  v_max_f32 v170, 0, v170
  v_max_f32 v171, 0, v171
  v_max_f32 v172, 0, v172
  v_max_f32 v173, 0, v173
  v_max_f32 v174, 0, v174
  v_max_f32 v175, 0, v175
  v_pk_mul_f32 v[168:169], v[168:169], v[168:169]
  v_pk_mul_f32 v[170:171], v[170:171], v[170:171]
  v_pk_mul_f32 v[172:173], v[172:173], v[172:173]
  v_pk_mul_f32 v[174:175], v[174:175], v[174:175]
  v_pk_mul_f32 v[168:169], v[168:169], v[24:25] op_sel_hi:[1,0]
  v_pk_mul_f32 v[170:171], v[170:171], v[24:25] op_sel_hi:[1,0]
  v_pk_mul_f32 v[172:173], v[172:173], v[26:27] op_sel_hi:[1,0]
  v_pk_mul_f32 v[174:175], v[174:175], v[26:27] op_sel_hi:[1,0]
  v_cvt_pk_bf16_f32 v168, v168, v169
  v_cvt_pk_bf16_f32 v169, v170, v171
  v_cvt_pk_bf16_f32 v170, v172, v173
  v_cvt_pk_bf16_f32 v171, v174, v175
  s_nop 1
  v_permlane16_swap_b32 v168, v170
  v_permlane16_swap_b32 v169, v171
  buffer_store_dwordx4 v[168:171], v5, s[20:23], s66 offen offset:1024
  v_max_f32 v176, 0, v176
  v_max_f32 v177, 0, v177
  v_max_f32 v178, 0, v178
  v_max_f32 v179, 0, v179
  v_max_f32 v180, 0, v180
  v_max_f32 v181, 0, v181
  v_max_f32 v182, 0, v182
  v_max_f32 v183, 0, v183
  v_pk_mul_f32 v[176:177], v[176:177], v[176:177]
  v_pk_mul_f32 v[178:179], v[178:179], v[178:179]
  v_pk_mul_f32 v[180:181], v[180:181], v[180:181]
  v_pk_mul_f32 v[182:183], v[182:183], v[182:183]
  v_pk_mul_f32 v[176:177], v[176:177], v[20:21] op_sel_hi:[1,0]
  v_pk_mul_f32 v[178:179], v[178:179], v[20:21] op_sel_hi:[1,0]
  v_pk_mul_f32 v[180:181], v[180:181], v[22:23] op_sel_hi:[1,0]
  v_pk_mul_f32 v[182:183], v[182:183], v[22:23] op_sel_hi:[1,0]
  v_cvt_pk_bf16_f32 v176, v176, v177
  v_cvt_pk_bf16_f32 v177, v178, v179
  v_cvt_pk_bf16_f32 v178, v180, v181
  v_cvt_pk_bf16_f32 v179, v182, v183
  s_nop 1
  v_permlane16_swap_b32 v176, v178
  v_permlane16_swap_b32 v177, v179
  buffer_store_dwordx4 v[176:179], v5, s[20:23], s63 offen offset:1536
  v_max_f32 v184, 0, v184
  v_max_f32 v185, 0, v185
  v_max_f32 v186, 0, v186
  v_max_f32 v187, 0, v187
  v_max_f32 v188, 0, v188
  v_max_f32 v189, 0, v189
  v_max_f32 v190, 0, v190
  v_max_f32 v191, 0, v191
  v_pk_mul_f32 v[184:185], v[184:185], v[184:185]
  v_pk_mul_f32 v[186:187], v[186:187], v[186:187]
  v_pk_mul_f32 v[188:189], v[188:189], v[188:189]
  v_pk_mul_f32 v[190:191], v[190:191], v[190:191]
  v_pk_mul_f32 v[184:185], v[184:185], v[24:25] op_sel_hi:[1,0]
  v_pk_mul_f32 v[186:187], v[186:187], v[24:25] op_sel_hi:[1,0]
  v_pk_mul_f32 v[188:189], v[188:189], v[26:27] op_sel_hi:[1,0]
  v_pk_mul_f32 v[190:191], v[190:191], v[26:27] op_sel_hi:[1,0]
  v_cvt_pk_bf16_f32 v184, v184, v185
  v_cvt_pk_bf16_f32 v185, v186, v187
  v_cvt_pk_bf16_f32 v186, v188, v189
  v_cvt_pk_bf16_f32 v187, v190, v191
  s_nop 1
  v_permlane16_swap_b32 v184, v186
  v_permlane16_swap_b32 v185, v187
  buffer_store_dwordx4 v[184:187], v5, s[20:23], s66 offen offset:1536
  v_max_f32 v192, 0, v192
  v_max_f32 v193, 0, v193
  v_max_f32 v194, 0, v194
  v_max_f32 v195, 0, v195
  v_max_f32 v196, 0, v196
  v_max_f32 v197, 0, v197
  v_max_f32 v198, 0, v198
  v_max_f32 v199, 0, v199
  v_pk_mul_f32 v[192:193], v[192:193], v[192:193]
  v_pk_mul_f32 v[194:195], v[194:195], v[194:195]
  v_pk_mul_f32 v[196:197], v[196:197], v[196:197]
  v_pk_mul_f32 v[198:199], v[198:199], v[198:199]
  v_pk_mul_f32 v[192:193], v[192:193], v[20:21] op_sel_hi:[1,0]
  v_pk_mul_f32 v[194:195], v[194:195], v[20:21] op_sel_hi:[1,0]
  v_pk_mul_f32 v[196:197], v[196:197], v[22:23] op_sel_hi:[1,0]
  v_pk_mul_f32 v[198:199], v[198:199], v[22:23] op_sel_hi:[1,0]
  v_cvt_pk_bf16_f32 v192, v192, v193
  v_cvt_pk_bf16_f32 v193, v194, v195
  v_cvt_pk_bf16_f32 v194, v196, v197
  v_cvt_pk_bf16_f32 v195, v198, v199
  s_nop 1
  v_permlane16_swap_b32 v192, v194
  v_permlane16_swap_b32 v193, v195
  buffer_store_dwordx4 v[192:195], v5, s[20:23], s63 offen offset:2048
  v_max_f32 v200, 0, v200
  v_max_f32 v201, 0, v201
  v_max_f32 v202, 0, v202
  v_max_f32 v203, 0, v203
  v_max_f32 v204, 0, v204
  v_max_f32 v205, 0, v205
  v_max_f32 v206, 0, v206
  v_max_f32 v207, 0, v207
  v_pk_mul_f32 v[200:201], v[200:201], v[200:201]
  v_pk_mul_f32 v[202:203], v[202:203], v[202:203]
  v_pk_mul_f32 v[204:205], v[204:205], v[204:205]
  v_pk_mul_f32 v[206:207], v[206:207], v[206:207]
  v_pk_mul_f32 v[200:201], v[200:201], v[24:25] op_sel_hi:[1,0]
  v_pk_mul_f32 v[202:203], v[202:203], v[24:25] op_sel_hi:[1,0]
  v_pk_mul_f32 v[204:205], v[204:205], v[26:27] op_sel_hi:[1,0]
  v_pk_mul_f32 v[206:207], v[206:207], v[26:27] op_sel_hi:[1,0]
  v_cvt_pk_bf16_f32 v200, v200, v201
  v_cvt_pk_bf16_f32 v201, v202, v203
  v_cvt_pk_bf16_f32 v202, v204, v205
  v_cvt_pk_bf16_f32 v203, v206, v207
  s_nop 1
  v_permlane16_swap_b32 v200, v202
  v_permlane16_swap_b32 v201, v203
  buffer_store_dwordx4 v[200:203], v5, s[20:23], s66 offen offset:2048
  v_max_f32 v208, 0, v208
  v_max_f32 v209, 0, v209
  v_max_f32 v210, 0, v210
  v_max_f32 v211, 0, v211
  v_max_f32 v212, 0, v212
  v_max_f32 v213, 0, v213
  v_max_f32 v214, 0, v214
  v_max_f32 v215, 0, v215
  v_pk_mul_f32 v[208:209], v[208:209], v[208:209]
  v_pk_mul_f32 v[210:211], v[210:211], v[210:211]
  v_pk_mul_f32 v[212:213], v[212:213], v[212:213]
  v_pk_mul_f32 v[214:215], v[214:215], v[214:215]
  v_pk_mul_f32 v[208:209], v[208:209], v[20:21] op_sel_hi:[1,0]
  v_pk_mul_f32 v[210:211], v[210:211], v[20:21] op_sel_hi:[1,0]
  v_pk_mul_f32 v[212:213], v[212:213], v[22:23] op_sel_hi:[1,0]
  v_pk_mul_f32 v[214:215], v[214:215], v[22:23] op_sel_hi:[1,0]
  v_cvt_pk_bf16_f32 v208, v208, v209
  v_cvt_pk_bf16_f32 v209, v210, v211
  v_cvt_pk_bf16_f32 v210, v212, v213
  v_cvt_pk_bf16_f32 v211, v214, v215
  s_nop 1
  v_permlane16_swap_b32 v208, v210
  v_permlane16_swap_b32 v209, v211
  buffer_store_dwordx4 v[208:211], v5, s[20:23], s63 offen offset:2560
  v_max_f32 v216, 0, v216
  v_max_f32 v217, 0, v217
  v_max_f32 v218, 0, v218
  v_max_f32 v219, 0, v219
  v_max_f32 v220, 0, v220
  v_max_f32 v221, 0, v221
  v_max_f32 v222, 0, v222
  v_max_f32 v223, 0, v223
  v_pk_mul_f32 v[216:217], v[216:217], v[216:217]
  v_pk_mul_f32 v[218:219], v[218:219], v[218:219]
  v_pk_mul_f32 v[220:221], v[220:221], v[220:221]
  v_pk_mul_f32 v[222:223], v[222:223], v[222:223]
  v_pk_mul_f32 v[216:217], v[216:217], v[24:25] op_sel_hi:[1,0]
  v_pk_mul_f32 v[218:219], v[218:219], v[24:25] op_sel_hi:[1,0]
  v_pk_mul_f32 v[220:221], v[220:221], v[26:27] op_sel_hi:[1,0]
  v_pk_mul_f32 v[222:223], v[222:223], v[26:27] op_sel_hi:[1,0]
  v_cvt_pk_bf16_f32 v216, v216, v217
  v_cvt_pk_bf16_f32 v217, v218, v219
  v_cvt_pk_bf16_f32 v218, v220, v221
  v_cvt_pk_bf16_f32 v219, v222, v223
  s_nop 1
  v_permlane16_swap_b32 v216, v218
  v_permlane16_swap_b32 v217, v219
  buffer_store_dwordx4 v[216:219], v5, s[20:23], s66 offen offset:2560
  s_endpgm
L_s1_end:
  s_endpgm
.globl s2_kernel
.p2align 8
.type s2_kernel,@function
s2_kernel:
  s_cmp_ge_u32 s2, 256
  s_cbranch_scc1 L_s2_end
  s_load_dwordx2 s[42:43], s[0:1], 56
  s_load_dwordx4 s[44:47], s[0:1], 72
  s_load_dwordx2 s[38:39], s[0:1], 88
  s_and_b32 s48, s2, 7
  s_lshr_b32 s49, s2, 3
  s_lshr_b32 s50, s48, 1
  s_lshl_b32 s50, s50, 3
  s_and_b32 s51, s49, 7
  s_add_u32 s50, s50, s51
  s_and_b32 s52, s48, 1
  s_lshl_b32 s52, s52, 2
  s_lshr_b32 s53, s49, 3
  s_add_u32 s33, s52, s53
  s_lshl_b32 s32, s50, 6
  s_lshl_b32 s34, s50, 2
  v_and_b32 v1, 63, v0
  v_lshrrev_b32 v2, 6, v0
  v_lshlrev_b32 v4, 4, v1
  v_readfirstlane_b32 s35, v2
  v_and_b32 v2, 15, v1
  v_lshrrev_b32 v3, 4, v1
  s_waitcnt lgkmcnt(0)
  s_mov_b32 s8, s38
  s_and_b32 s9, s39, 0xffff
  s_mov_b32 s10, 0x1800000
  s_mov_b32 s11, 0x00020000
  s_mov_b32 s20, s42
  s_and_b32 s21, s43, 0xffff
  s_mov_b32 s22, 0x500
  s_mov_b32 s23, 0x00020000
  s_mov_b32 s24, s44
  s_and_b32 s25, s45, 0xffff
  s_mov_b32 s26, 0x280000
  s_mov_b32 s27, 0x00020000
  s_mov_b32 s28, s46
  s_and_b32 s29, s47, 0xffff
  s_mov_b32 s30, 0x100
  s_mov_b32 s31, 0x00020000
  s_cmp_ge_u32 s35, 4
  s_cbranch_scc1 L_s2_awave
  s_mul_i32 s55, s34, 192
  s_mul_i32 s60, s35, 48
  s_add_u32 s55, s55, s60
  s_lshl_b32 s55, s55, 8
  s_add_u32 s55, s55, 0x1000000
  s_mul_i32 s56, s35, 480
  s_mul_i32 s60, s33, 5
  s_add_u32 s56, s56, s60
  s_lshl_b32 s56, s56, 10
  s_add_u32 s56, s56, 0xc00000
  s_mul_i32 s57, s35, 200
  s_add_u32 s57, s57, s60
  s_lshl_b32 s57, s57, 10
  s_add_u32 s57, s57, 0xe00000
  v_add_u32 v5, 4096, v4
  s_mul_i32 s59, s53, 3
  s_add_u32 s59, s59, s51
  s_lshr_b32 s60, s51, 1
  s_add_u32 s59, s59, s60
  s_cmp_ge_u32 s59, 12
  s_cselect_b32 s60, 12, 0
  s_mov_b32 s59, 0
  s_lshl_b32 s60, s59, 10
  s_add_u32 s55, s55, s60
  s_mul_i32 s60, s59, 40960
  s_add_u32 s56, s56, s60
  s_mov_b32 s66, 4294956032
  s_mov_b32 s67, 1024
  s_mov_b32 s68, 4294516736
  s_mov_b32 s69, 40960
  v_add_u32 v232, 0, v4
  v_add_u32 v233, 49152, v4
  v_add_u32 v234, 98304, v4
  v_add_u32 v235, 147456, v4
  s_cmp_ge_u32 s2, 32
  s_cbranch_scc1 L_s2_bgo
  s_barrier
L_s2_bgo:
  buffer_load_dwordx4 v[24:27], v4, s[8:11], s56 offen offset:0
  buffer_load_dwordx4 v[8:11], v232, s[8:11], s55 offen
  buffer_load_dwordx4 v[12:15], v233, s[8:11], s55 offen
  buffer_load_dwordx4 v[16:19], v234, s[8:11], s55 offen
  buffer_load_dwordx4 v[20:23], v235, s[8:11], s55 offen
  buffer_load_dwordx4 v[28:31], v4, s[8:11], s56 offen offset:1024
  buffer_load_dwordx4 v[32:35], v4, s[8:11], s56 offen offset:2048
  buffer_load_dwordx4 v[36:39], v4, s[8:11], s56 offen offset:3072
  buffer_load_dwordx4 v[40:43], v5, s[8:11], s56 offen
  s_add_u32 s59, s59, 1
  s_cmp_eq_u32 s59, 12
  s_cselect_b32 s64, s66, s67
  s_cselect_b32 s65, s68, s69
  s_add_u32 s55, s55, s64
  s_add_u32 s56, s56, s65
  buffer_load_dwordx4 v[60:63], v4, s[8:11], s56 offen offset:0
  buffer_load_dwordx4 v[44:47], v232, s[8:11], s55 offen
  buffer_load_dwordx4 v[48:51], v233, s[8:11], s55 offen
  buffer_load_dwordx4 v[52:55], v234, s[8:11], s55 offen
  buffer_load_dwordx4 v[56:59], v235, s[8:11], s55 offen
  buffer_load_dwordx4 v[64:67], v4, s[8:11], s56 offen offset:1024
  buffer_load_dwordx4 v[68:71], v4, s[8:11], s56 offen offset:2048
  buffer_load_dwordx4 v[72:75], v4, s[8:11], s56 offen offset:3072
  buffer_load_dwordx4 v[76:79], v5, s[8:11], s56 offen
  s_add_u32 s59, s59, 1
  s_cmp_eq_u32 s59, 12
  s_cselect_b32 s64, s66, s67
  s_cselect_b32 s65, s68, s69
  s_add_u32 s55, s55, s64
  s_add_u32 s56, s56, s65
  s_lshl_b32 s60, s35, 4
  s_add_u32 s60, s60, s32
  v_add_u32 v6, s60, v2
  v_lshlrev_b32 v7, 2, v6
  v_add_u32 v7, 0xa10000, v7
  buffer_load_dword v236, v7, s[8:11], 0 offen
  s_mul_i32 s58, s33, 160
  v_lshlrev_b32 v7, 3, v3
  buffer_load_dwordx2 v[238:239], v7, s[20:23], s58 offen offset:0
  buffer_load_dwordx2 v[240:241], v7, s[20:23], s58 offen offset:32
  buffer_load_dwordx2 v[242:243], v7, s[20:23], s58 offen offset:64
  buffer_load_dwordx2 v[244:245], v7, s[20:23], s58 offen offset:96
  buffer_load_dwordx2 v[246:247], v7, s[20:23], s58 offen offset:128
  v_pk_mov_b32 v[152:153], 0, 0
  v_pk_mov_b32 v[154:155], 0, 0
  v_pk_mov_b32 v[156:157], 0, 0
  v_pk_mov_b32 v[158:159], 0, 0
  v_pk_mov_b32 v[160:161], 0, 0
  v_pk_mov_b32 v[162:163], 0, 0
  v_pk_mov_b32 v[164:165], 0, 0
  v_pk_mov_b32 v[166:167], 0, 0
  v_pk_mov_b32 v[168:169], 0, 0
  v_pk_mov_b32 v[170:171], 0, 0
  v_pk_mov_b32 v[172:173], 0, 0
  v_pk_mov_b32 v[174:175], 0, 0
  v_pk_mov_b32 v[176:177], 0, 0
  v_pk_mov_b32 v[178:179], 0, 0
  v_pk_mov_b32 v[180:181], 0, 0
  v_pk_mov_b32 v[182:183], 0, 0
  v_pk_mov_b32 v[184:185], 0, 0
  v_pk_mov_b32 v[186:187], 0, 0
  v_pk_mov_b32 v[188:189], 0, 0
  v_pk_mov_b32 v[190:191], 0, 0
  v_pk_mov_b32 v[192:193], 0, 0
  v_pk_mov_b32 v[194:195], 0, 0
  v_pk_mov_b32 v[196:197], 0, 0
  v_pk_mov_b32 v[198:199], 0, 0
  v_pk_mov_b32 v[200:201], 0, 0
  v_pk_mov_b32 v[202:203], 0, 0
  v_pk_mov_b32 v[204:205], 0, 0
  v_pk_mov_b32 v[206:207], 0, 0
  v_pk_mov_b32 v[208:209], 0, 0
  v_pk_mov_b32 v[210:211], 0, 0
  v_pk_mov_b32 v[212:213], 0, 0
  v_pk_mov_b32 v[214:215], 0, 0
  v_pk_mov_b32 v[216:217], 0, 0
  v_pk_mov_b32 v[218:219], 0, 0
  v_pk_mov_b32 v[220:221], 0, 0
  v_pk_mov_b32 v[222:223], 0, 0
  v_pk_mov_b32 v[224:225], 0, 0
  v_pk_mov_b32 v[226:227], 0, 0
  v_pk_mov_b32 v[228:229], 0, 0
  v_pk_mov_b32 v[230:231], 0, 0
  s_mul_i32 s60, s35, 20480
  v_add_u32 v7, s60, v4
  s_waitcnt vmcnt(15)
  buffer_load_dwordx4 v[96:99], v4, s[8:11], s56 offen offset:0
  buffer_load_dwordx4 v[80:83], v232, s[8:11], s55 offen
  buffer_load_dwordx4 v[84:87], v233, s[8:11], s55 offen
  buffer_load_dwordx4 v[88:91], v234, s[8:11], s55 offen
  buffer_load_dwordx4 v[92:95], v235, s[8:11], s55 offen
  buffer_load_dwordx4 v[100:103], v4, s[8:11], s56 offen offset:1024
  buffer_load_dwordx4 v[104:107], v4, s[8:11], s56 offen offset:2048
  buffer_load_dwordx4 v[108:111], v4, s[8:11], s56 offen offset:3072
  buffer_load_dwordx4 v[112:115], v5, s[8:11], s56 offen
  s_add_u32 s59, s59, 1
  s_cmp_eq_u32 s59, 12
  s_cselect_b32 s64, s66, s67
  s_cselect_b32 s65, s68, s69
  s_add_u32 s55, s55, s64
  s_add_u32 s56, s56, s65
  buffer_load_dwordx4 v[132:135], v4, s[8:11], s56 offen offset:0
  buffer_load_dwordx4 v[116:119], v232, s[8:11], s55 offen
  buffer_load_dwordx4 v[120:123], v233, s[8:11], s55 offen
  buffer_load_dwordx4 v[124:127], v234, s[8:11], s55 offen
  buffer_load_dwordx4 v[128:131], v235, s[8:11], s55 offen
  buffer_load_dwordx4 v[136:139], v4, s[8:11], s56 offen offset:1024
  buffer_load_dwordx4 v[140:143], v4, s[8:11], s56 offen offset:2048
  buffer_load_dwordx4 v[144:147], v4, s[8:11], s56 offen offset:3072
  buffer_load_dwordx4 v[148:151], v5, s[8:11], s56 offen
  s_add_u32 s59, s59, 1
  s_cmp_eq_u32 s59, 12
  s_cselect_b32 s64, s66, s67
  s_cselect_b32 s65, s68, s69
  s_add_u32 s55, s55, s64
  s_add_u32 s56, s56, s65
  v_mfma_f32_16x16x32_bf16 v[152:155], v[24:27], v[8:11], v[152:155]
  v_mfma_f32_16x16x32_bf16 v[156:159], v[24:27], v[12:15], v[156:159]
  v_mfma_f32_16x16x32_bf16 v[160:163], v[24:27], v[16:19], v[160:163]
  v_mfma_f32_16x16x32_bf16 v[164:167], v[24:27], v[20:23], v[164:167]
  v_mfma_f32_16x16x32_bf16 v[168:171], v[28:31], v[8:11], v[168:171]
  v_mfma_f32_16x16x32_bf16 v[172:175], v[28:31], v[12:15], v[172:175]
  v_mfma_f32_16x16x32_bf16 v[176:179], v[28:31], v[16:19], v[176:179]
  v_mfma_f32_16x16x32_bf16 v[180:183], v[28:31], v[20:23], v[180:183]
  v_mfma_f32_16x16x32_bf16 v[184:187], v[32:35], v[8:11], v[184:187]
  v_mfma_f32_16x16x32_bf16 v[188:191], v[32:35], v[12:15], v[188:191]
  v_mfma_f32_16x16x32_bf16 v[192:195], v[32:35], v[16:19], v[192:195]
  v_mfma_f32_16x16x32_bf16 v[196:199], v[32:35], v[20:23], v[196:199]
  v_mfma_f32_16x16x32_bf16 v[200:203], v[36:39], v[8:11], v[200:203]
  v_mfma_f32_16x16x32_bf16 v[204:207], v[36:39], v[12:15], v[204:207]
  v_mfma_f32_16x16x32_bf16 v[208:211], v[36:39], v[16:19], v[208:211]
  v_mfma_f32_16x16x32_bf16 v[212:215], v[36:39], v[20:23], v[212:215]
  v_mfma_f32_16x16x32_bf16 v[216:219], v[40:43], v[8:11], v[216:219]
  v_mfma_f32_16x16x32_bf16 v[220:223], v[40:43], v[12:15], v[220:223]
  v_mfma_f32_16x16x32_bf16 v[224:227], v[40:43], v[16:19], v[224:227]
  v_mfma_f32_16x16x32_bf16 v[228:231], v[40:43], v[20:23], v[228:231]
  s_waitcnt vmcnt(24)
  buffer_load_dwordx4 v[24:27], v4, s[8:11], s56 offen offset:0
  buffer_load_dwordx4 v[8:11], v232, s[8:11], s55 offen
  buffer_load_dwordx4 v[12:15], v233, s[8:11], s55 offen
  buffer_load_dwordx4 v[16:19], v234, s[8:11], s55 offen
  buffer_load_dwordx4 v[20:23], v235, s[8:11], s55 offen
  buffer_load_dwordx4 v[28:31], v4, s[8:11], s56 offen offset:1024
  buffer_load_dwordx4 v[32:35], v4, s[8:11], s56 offen offset:2048
  buffer_load_dwordx4 v[36:39], v4, s[8:11], s56 offen offset:3072
  buffer_load_dwordx4 v[40:43], v5, s[8:11], s56 offen
  s_add_u32 s59, s59, 1
  s_cmp_eq_u32 s59, 12
  s_cselect_b32 s64, s66, s67
  s_cselect_b32 s65, s68, s69
  s_add_u32 s55, s55, s64
  s_add_u32 s56, s56, s65
  v_mfma_f32_16x16x32_bf16 v[152:155], v[60:63], v[44:47], v[152:155]
  v_mfma_f32_16x16x32_bf16 v[156:159], v[60:63], v[48:51], v[156:159]
  v_mfma_f32_16x16x32_bf16 v[160:163], v[60:63], v[52:55], v[160:163]
  v_mfma_f32_16x16x32_bf16 v[164:167], v[60:63], v[56:59], v[164:167]
  v_mfma_f32_16x16x32_bf16 v[168:171], v[64:67], v[44:47], v[168:171]
  v_mfma_f32_16x16x32_bf16 v[172:175], v[64:67], v[48:51], v[172:175]
  v_mfma_f32_16x16x32_bf16 v[176:179], v[64:67], v[52:55], v[176:179]
  v_mfma_f32_16x16x32_bf16 v[180:183], v[64:67], v[56:59], v[180:183]
  v_mfma_f32_16x16x32_bf16 v[184:187], v[68:71], v[44:47], v[184:187]
  v_mfma_f32_16x16x32_bf16 v[188:191], v[68:71], v[48:51], v[188:191]
  v_mfma_f32_16x16x32_bf16 v[192:195], v[68:71], v[52:55], v[192:195]
  v_mfma_f32_16x16x32_bf16 v[196:199], v[68:71], v[56:59], v[196:199]
  v_mfma_f32_16x16x32_bf16 v[200:203], v[72:75], v[44:47], v[200:203]
  v_mfma_f32_16x16x32_bf16 v[204:207], v[72:75], v[48:51], v[204:207]
  v_mfma_f32_16x16x32_bf16 v[208:211], v[72:75], v[52:55], v[208:211]
  v_mfma_f32_16x16x32_bf16 v[212:215], v[72:75], v[56:59], v[212:215]
  v_mfma_f32_16x16x32_bf16 v[216:219], v[76:79], v[44:47], v[216:219]
  v_mfma_f32_16x16x32_bf16 v[220:223], v[76:79], v[48:51], v[220:223]
  v_mfma_f32_16x16x32_bf16 v[224:227], v[76:79], v[52:55], v[224:227]
  v_mfma_f32_16x16x32_bf16 v[228:231], v[76:79], v[56:59], v[228:231]
  s_waitcnt vmcnt(18)
  buffer_load_dwordx4 v[60:63], v4, s[8:11], s57 offen offset:0
  buffer_load_dwordx4 v[64:67], v4, s[8:11], s57 offen offset:1024
  buffer_load_dwordx4 v[68:71], v4, s[8:11], s57 offen offset:2048
  buffer_load_dwordx4 v[72:75], v4, s[8:11], s57 offen offset:3072
  buffer_load_dwordx4 v[76:79], v5, s[8:11], s57 offen
  s_add_u32 s57, s57, 40960
  v_mfma_f32_16x16x32_bf16 v[152:155], v[96:99], v[80:83], v[152:155]
  v_mfma_f32_16x16x32_bf16 v[156:159], v[96:99], v[84:87], v[156:159]
  v_mfma_f32_16x16x32_bf16 v[160:163], v[96:99], v[88:91], v[160:163]
  v_mfma_f32_16x16x32_bf16 v[164:167], v[96:99], v[92:95], v[164:167]
  v_mfma_f32_16x16x32_bf16 v[168:171], v[100:103], v[80:83], v[168:171]
  v_mfma_f32_16x16x32_bf16 v[172:175], v[100:103], v[84:87], v[172:175]
  v_mfma_f32_16x16x32_bf16 v[176:179], v[100:103], v[88:91], v[176:179]
  v_mfma_f32_16x16x32_bf16 v[180:183], v[100:103], v[92:95], v[180:183]
  v_mfma_f32_16x16x32_bf16 v[184:187], v[104:107], v[80:83], v[184:187]
  v_mfma_f32_16x16x32_bf16 v[188:191], v[104:107], v[84:87], v[188:191]
  v_mfma_f32_16x16x32_bf16 v[192:195], v[104:107], v[88:91], v[192:195]
  v_mfma_f32_16x16x32_bf16 v[196:199], v[104:107], v[92:95], v[196:199]
  v_mfma_f32_16x16x32_bf16 v[200:203], v[108:111], v[80:83], v[200:203]
  v_mfma_f32_16x16x32_bf16 v[204:207], v[108:111], v[84:87], v[204:207]
  v_mfma_f32_16x16x32_bf16 v[208:211], v[108:111], v[88:91], v[208:211]
  v_mfma_f32_16x16x32_bf16 v[212:215], v[108:111], v[92:95], v[212:215]
  v_mfma_f32_16x16x32_bf16 v[216:219], v[112:115], v[80:83], v[216:219]
  v_mfma_f32_16x16x32_bf16 v[220:223], v[112:115], v[84:87], v[220:223]
  v_mfma_f32_16x16x32_bf16 v[224:227], v[112:115], v[88:91], v[224:227]
  v_mfma_f32_16x16x32_bf16 v[228:231], v[112:115], v[92:95], v[228:231]
  s_waitcnt vmcnt(14)
  buffer_load_dwordx4 v[96:99], v4, s[8:11], s57 offen offset:0
  buffer_load_dwordx4 v[100:103], v4, s[8:11], s57 offen offset:1024
  buffer_load_dwordx4 v[104:107], v4, s[8:11], s57 offen offset:2048
  buffer_load_dwordx4 v[108:111], v4, s[8:11], s57 offen offset:3072
  buffer_load_dwordx4 v[112:115], v5, s[8:11], s57 offen
  s_add_u32 s57, s57, 40960
  v_mfma_f32_16x16x32_bf16 v[152:155], v[132:135], v[116:119], v[152:155]
  v_mfma_f32_16x16x32_bf16 v[156:159], v[132:135], v[120:123], v[156:159]
  v_mfma_f32_16x16x32_bf16 v[160:163], v[132:135], v[124:127], v[160:163]
  v_mfma_f32_16x16x32_bf16 v[164:167], v[132:135], v[128:131], v[164:167]
  v_mfma_f32_16x16x32_bf16 v[168:171], v[136:139], v[116:119], v[168:171]
  v_mfma_f32_16x16x32_bf16 v[172:175], v[136:139], v[120:123], v[172:175]
  v_mfma_f32_16x16x32_bf16 v[176:179], v[136:139], v[124:127], v[176:179]
  v_mfma_f32_16x16x32_bf16 v[180:183], v[136:139], v[128:131], v[180:183]
  v_mfma_f32_16x16x32_bf16 v[184:187], v[140:143], v[116:119], v[184:187]
  v_mfma_f32_16x16x32_bf16 v[188:191], v[140:143], v[120:123], v[188:191]
  v_mfma_f32_16x16x32_bf16 v[192:195], v[140:143], v[124:127], v[192:195]
  v_mfma_f32_16x16x32_bf16 v[196:199], v[140:143], v[128:131], v[196:199]
  v_mfma_f32_16x16x32_bf16 v[200:203], v[144:147], v[116:119], v[200:203]
  v_mfma_f32_16x16x32_bf16 v[204:207], v[144:147], v[120:123], v[204:207]
  v_mfma_f32_16x16x32_bf16 v[208:211], v[144:147], v[124:127], v[208:211]
  v_mfma_f32_16x16x32_bf16 v[212:215], v[144:147], v[128:131], v[212:215]
  v_mfma_f32_16x16x32_bf16 v[216:219], v[148:151], v[116:119], v[216:219]
  v_mfma_f32_16x16x32_bf16 v[220:223], v[148:151], v[120:123], v[220:223]
  v_mfma_f32_16x16x32_bf16 v[224:227], v[148:151], v[124:127], v[224:227]
  v_mfma_f32_16x16x32_bf16 v[228:231], v[148:151], v[128:131], v[228:231]
  s_waitcnt vmcnt(10)
  buffer_load_dwordx4 v[132:135], v4, s[8:11], s56 offen offset:0
  buffer_load_dwordx4 v[116:119], v232, s[8:11], s55 offen
  buffer_load_dwordx4 v[120:123], v233, s[8:11], s55 offen
  buffer_load_dwordx4 v[124:127], v234, s[8:11], s55 offen
  buffer_load_dwordx4 v[128:131], v235, s[8:11], s55 offen
  buffer_load_dwordx4 v[136:139], v4, s[8:11], s56 offen offset:1024
  buffer_load_dwordx4 v[140:143], v4, s[8:11], s56 offen offset:2048
  buffer_load_dwordx4 v[144:147], v4, s[8:11], s56 offen offset:3072
  buffer_load_dwordx4 v[148:151], v5, s[8:11], s56 offen
  s_add_u32 s59, s59, 1
  s_cmp_eq_u32 s59, 12
  s_cselect_b32 s64, s66, s67
  s_cselect_b32 s65, s68, s69
  s_add_u32 s55, s55, s64
  s_add_u32 s56, s56, s65
  v_mfma_f32_16x16x32_bf16 v[152:155], v[24:27], v[8:11], v[152:155]
  v_mfma_f32_16x16x32_bf16 v[156:159], v[24:27], v[12:15], v[156:159]
  v_mfma_f32_16x16x32_bf16 v[160:163], v[24:27], v[16:19], v[160:163]
  v_mfma_f32_16x16x32_bf16 v[164:167], v[24:27], v[20:23], v[164:167]
  v_mfma_f32_16x16x32_bf16 v[168:171], v[28:31], v[8:11], v[168:171]
  v_mfma_f32_16x16x32_bf16 v[172:175], v[28:31], v[12:15], v[172:175]
  v_mfma_f32_16x16x32_bf16 v[176:179], v[28:31], v[16:19], v[176:179]
  v_mfma_f32_16x16x32_bf16 v[180:183], v[28:31], v[20:23], v[180:183]
  v_mfma_f32_16x16x32_bf16 v[184:187], v[32:35], v[8:11], v[184:187]
  v_mfma_f32_16x16x32_bf16 v[188:191], v[32:35], v[12:15], v[188:191]
  v_mfma_f32_16x16x32_bf16 v[192:195], v[32:35], v[16:19], v[192:195]
  v_mfma_f32_16x16x32_bf16 v[196:199], v[32:35], v[20:23], v[196:199]
  v_mfma_f32_16x16x32_bf16 v[200:203], v[36:39], v[8:11], v[200:203]
  v_mfma_f32_16x16x32_bf16 v[204:207], v[36:39], v[12:15], v[204:207]
  v_mfma_f32_16x16x32_bf16 v[208:211], v[36:39], v[16:19], v[208:211]
  v_mfma_f32_16x16x32_bf16 v[212:215], v[36:39], v[20:23], v[212:215]
  v_mfma_f32_16x16x32_bf16 v[216:219], v[40:43], v[8:11], v[216:219]
  v_mfma_f32_16x16x32_bf16 v[220:223], v[40:43], v[12:15], v[220:223]
  v_mfma_f32_16x16x32_bf16 v[224:227], v[40:43], v[16:19], v[224:227]
  v_mfma_f32_16x16x32_bf16 v[228:231], v[40:43], v[20:23], v[228:231]
  s_barrier
  ds_read_b128 v[44:47], v7 offset:0
  ds_read_b128 v[48:51], v7 offset:5120
  ds_read_b128 v[52:55], v7 offset:10240
  ds_read_b128 v[56:59], v7 offset:15360
  s_waitcnt vmcnt(14)
  buffer_load_dwordx4 v[24:27], v4, s[8:11], s56 offen offset:0
  buffer_load_dwordx4 v[8:11], v232, s[8:11], s55 offen
  buffer_load_dwordx4 v[12:15], v233, s[8:11], s55 offen
  buffer_load_dwordx4 v[16:19], v234, s[8:11], s55 offen
  buffer_load_dwordx4 v[20:23], v235, s[8:11], s55 offen
  buffer_load_dwordx4 v[28:31], v4, s[8:11], s56 offen offset:1024
  buffer_load_dwordx4 v[32:35], v4, s[8:11], s56 offen offset:2048
  buffer_load_dwordx4 v[36:39], v4, s[8:11], s56 offen offset:3072
  buffer_load_dwordx4 v[40:43], v5, s[8:11], s56 offen
  s_add_u32 s59, s59, 1
  s_cmp_eq_u32 s59, 12
  s_cselect_b32 s64, s66, s67
  s_cselect_b32 s65, s68, s69
  s_add_u32 s55, s55, s64
  s_add_u32 s56, s56, s65
  s_waitcnt lgkmcnt(0)
  v_mfma_f32_16x16x32_bf16 v[152:155], v[60:63], v[44:47], v[152:155]
  v_mfma_f32_16x16x32_bf16 v[156:159], v[60:63], v[48:51], v[156:159]
  v_mfma_f32_16x16x32_bf16 v[160:163], v[60:63], v[52:55], v[160:163]
  v_mfma_f32_16x16x32_bf16 v[164:167], v[60:63], v[56:59], v[164:167]
  v_mfma_f32_16x16x32_bf16 v[168:171], v[64:67], v[44:47], v[168:171]
  v_mfma_f32_16x16x32_bf16 v[172:175], v[64:67], v[48:51], v[172:175]
  v_mfma_f32_16x16x32_bf16 v[176:179], v[64:67], v[52:55], v[176:179]
  v_mfma_f32_16x16x32_bf16 v[180:183], v[64:67], v[56:59], v[180:183]
  v_mfma_f32_16x16x32_bf16 v[184:187], v[68:71], v[44:47], v[184:187]
  v_mfma_f32_16x16x32_bf16 v[188:191], v[68:71], v[48:51], v[188:191]
  v_mfma_f32_16x16x32_bf16 v[192:195], v[68:71], v[52:55], v[192:195]
  v_mfma_f32_16x16x32_bf16 v[196:199], v[68:71], v[56:59], v[196:199]
  v_mfma_f32_16x16x32_bf16 v[200:203], v[72:75], v[44:47], v[200:203]
  v_mfma_f32_16x16x32_bf16 v[204:207], v[72:75], v[48:51], v[204:207]
  v_mfma_f32_16x16x32_bf16 v[208:211], v[72:75], v[52:55], v[208:211]
  v_mfma_f32_16x16x32_bf16 v[212:215], v[72:75], v[56:59], v[212:215]
  v_mfma_f32_16x16x32_bf16 v[216:219], v[76:79], v[44:47], v[216:219]
  v_mfma_f32_16x16x32_bf16 v[220:223], v[76:79], v[48:51], v[220:223]
  v_mfma_f32_16x16x32_bf16 v[224:227], v[76:79], v[52:55], v[224:227]
  v_mfma_f32_16x16x32_bf16 v[228:231], v[76:79], v[56:59], v[228:231]
  ds_read_b128 v[80:83], v7 offset:1024
  ds_read_b128 v[84:87], v7 offset:6144
  ds_read_b128 v[88:91], v7 offset:11264
  ds_read_b128 v[92:95], v7 offset:16384
  s_waitcnt vmcnt(18)
  buffer_load_dwordx4 v[60:63], v4, s[8:11], s56 offen offset:0
  buffer_load_dwordx4 v[44:47], v232, s[8:11], s55 offen
  buffer_load_dwordx4 v[48:51], v233, s[8:11], s55 offen
  buffer_load_dwordx4 v[52:55], v234, s[8:11], s55 offen
  buffer_load_dwordx4 v[56:59], v235, s[8:11], s55 offen
  buffer_load_dwordx4 v[64:67], v4, s[8:11], s56 offen offset:1024
  buffer_load_dwordx4 v[68:71], v4, s[8:11], s56 offen offset:2048
  buffer_load_dwordx4 v[72:75], v4, s[8:11], s56 offen offset:3072
  buffer_load_dwordx4 v[76:79], v5, s[8:11], s56 offen
  s_add_u32 s59, s59, 1
  s_cmp_eq_u32 s59, 12
  s_cselect_b32 s64, s66, s67
  s_cselect_b32 s65, s68, s69
  s_add_u32 s55, s55, s64
  s_add_u32 s56, s56, s65
  s_waitcnt lgkmcnt(0)
  v_mfma_f32_16x16x32_bf16 v[152:155], v[96:99], v[80:83], v[152:155]
  v_mfma_f32_16x16x32_bf16 v[156:159], v[96:99], v[84:87], v[156:159]
  v_mfma_f32_16x16x32_bf16 v[160:163], v[96:99], v[88:91], v[160:163]
  v_mfma_f32_16x16x32_bf16 v[164:167], v[96:99], v[92:95], v[164:167]
  v_mfma_f32_16x16x32_bf16 v[168:171], v[100:103], v[80:83], v[168:171]
  v_mfma_f32_16x16x32_bf16 v[172:175], v[100:103], v[84:87], v[172:175]
  v_mfma_f32_16x16x32_bf16 v[176:179], v[100:103], v[88:91], v[176:179]
  v_mfma_f32_16x16x32_bf16 v[180:183], v[100:103], v[92:95], v[180:183]
  v_mfma_f32_16x16x32_bf16 v[184:187], v[104:107], v[80:83], v[184:187]
  v_mfma_f32_16x16x32_bf16 v[188:191], v[104:107], v[84:87], v[188:191]
  v_mfma_f32_16x16x32_bf16 v[192:195], v[104:107], v[88:91], v[192:195]
  v_mfma_f32_16x16x32_bf16 v[196:199], v[104:107], v[92:95], v[196:199]
  v_mfma_f32_16x16x32_bf16 v[200:203], v[108:111], v[80:83], v[200:203]
  v_mfma_f32_16x16x32_bf16 v[204:207], v[108:111], v[84:87], v[204:207]
  v_mfma_f32_16x16x32_bf16 v[208:211], v[108:111], v[88:91], v[208:211]
  v_mfma_f32_16x16x32_bf16 v[212:215], v[108:111], v[92:95], v[212:215]
  v_mfma_f32_16x16x32_bf16 v[216:219], v[112:115], v[80:83], v[216:219]
  v_mfma_f32_16x16x32_bf16 v[220:223], v[112:115], v[84:87], v[220:223]
  v_mfma_f32_16x16x32_bf16 v[224:227], v[112:115], v[88:91], v[224:227]
  v_mfma_f32_16x16x32_bf16 v[228:231], v[112:115], v[92:95], v[228:231]
  s_waitcnt vmcnt(18)
  buffer_load_dwordx4 v[96:99], v4, s[8:11], s56 offen offset:0
  buffer_load_dwordx4 v[80:83], v232, s[8:11], s55 offen
  buffer_load_dwordx4 v[84:87], v233, s[8:11], s55 offen
  buffer_load_dwordx4 v[88:91], v234, s[8:11], s55 offen
  buffer_load_dwordx4 v[92:95], v235, s[8:11], s55 offen
  buffer_load_dwordx4 v[100:103], v4, s[8:11], s56 offen offset:1024
  buffer_load_dwordx4 v[104:107], v4, s[8:11], s56 offen offset:2048
  buffer_load_dwordx4 v[108:111], v4, s[8:11], s56 offen offset:3072
  buffer_load_dwordx4 v[112:115], v5, s[8:11], s56 offen
  s_add_u32 s59, s59, 1
  s_cmp_eq_u32 s59, 12
  s_cselect_b32 s64, s66, s67
  s_cselect_b32 s65, s68, s69
  s_add_u32 s55, s55, s64
  s_add_u32 s56, s56, s65
  v_mfma_f32_16x16x32_bf16 v[152:155], v[132:135], v[116:119], v[152:155]
  v_mfma_f32_16x16x32_bf16 v[156:159], v[132:135], v[120:123], v[156:159]
  v_mfma_f32_16x16x32_bf16 v[160:163], v[132:135], v[124:127], v[160:163]
  v_mfma_f32_16x16x32_bf16 v[164:167], v[132:135], v[128:131], v[164:167]
  v_mfma_f32_16x16x32_bf16 v[168:171], v[136:139], v[116:119], v[168:171]
  v_mfma_f32_16x16x32_bf16 v[172:175], v[136:139], v[120:123], v[172:175]
  v_mfma_f32_16x16x32_bf16 v[176:179], v[136:139], v[124:127], v[176:179]
  v_mfma_f32_16x16x32_bf16 v[180:183], v[136:139], v[128:131], v[180:183]
  v_mfma_f32_16x16x32_bf16 v[184:187], v[140:143], v[116:119], v[184:187]
  v_mfma_f32_16x16x32_bf16 v[188:191], v[140:143], v[120:123], v[188:191]
  v_mfma_f32_16x16x32_bf16 v[192:195], v[140:143], v[124:127], v[192:195]
  v_mfma_f32_16x16x32_bf16 v[196:199], v[140:143], v[128:131], v[196:199]
  v_mfma_f32_16x16x32_bf16 v[200:203], v[144:147], v[116:119], v[200:203]
  v_mfma_f32_16x16x32_bf16 v[204:207], v[144:147], v[120:123], v[204:207]
  v_mfma_f32_16x16x32_bf16 v[208:211], v[144:147], v[124:127], v[208:211]
  v_mfma_f32_16x16x32_bf16 v[212:215], v[144:147], v[128:131], v[212:215]
  v_mfma_f32_16x16x32_bf16 v[216:219], v[148:151], v[116:119], v[216:219]
  v_mfma_f32_16x16x32_bf16 v[220:223], v[148:151], v[120:123], v[220:223]
  v_mfma_f32_16x16x32_bf16 v[224:227], v[148:151], v[124:127], v[224:227]
  v_mfma_f32_16x16x32_bf16 v[228:231], v[148:151], v[128:131], v[228:231]
  s_waitcnt vmcnt(18)
  buffer_load_dwordx4 v[132:135], v4, s[8:11], s57 offen offset:0
  buffer_load_dwordx4 v[136:139], v4, s[8:11], s57 offen offset:1024
  buffer_load_dwordx4 v[140:143], v4, s[8:11], s57 offen offset:2048
  buffer_load_dwordx4 v[144:147], v4, s[8:11], s57 offen offset:3072
  buffer_load_dwordx4 v[148:151], v5, s[8:11], s57 offen
  s_add_u32 s57, s57, 40960
  v_mfma_f32_16x16x32_bf16 v[152:155], v[24:27], v[8:11], v[152:155]
  v_mfma_f32_16x16x32_bf16 v[156:159], v[24:27], v[12:15], v[156:159]
  v_mfma_f32_16x16x32_bf16 v[160:163], v[24:27], v[16:19], v[160:163]
  v_mfma_f32_16x16x32_bf16 v[164:167], v[24:27], v[20:23], v[164:167]
  v_mfma_f32_16x16x32_bf16 v[168:171], v[28:31], v[8:11], v[168:171]
  v_mfma_f32_16x16x32_bf16 v[172:175], v[28:31], v[12:15], v[172:175]
  v_mfma_f32_16x16x32_bf16 v[176:179], v[28:31], v[16:19], v[176:179]
  v_mfma_f32_16x16x32_bf16 v[180:183], v[28:31], v[20:23], v[180:183]
  v_mfma_f32_16x16x32_bf16 v[184:187], v[32:35], v[8:11], v[184:187]
  v_mfma_f32_16x16x32_bf16 v[188:191], v[32:35], v[12:15], v[188:191]
  v_mfma_f32_16x16x32_bf16 v[192:195], v[32:35], v[16:19], v[192:195]
  v_mfma_f32_16x16x32_bf16 v[196:199], v[32:35], v[20:23], v[196:199]
  v_mfma_f32_16x16x32_bf16 v[200:203], v[36:39], v[8:11], v[200:203]
  v_mfma_f32_16x16x32_bf16 v[204:207], v[36:39], v[12:15], v[204:207]
  v_mfma_f32_16x16x32_bf16 v[208:211], v[36:39], v[16:19], v[208:211]
  v_mfma_f32_16x16x32_bf16 v[212:215], v[36:39], v[20:23], v[212:215]
  v_mfma_f32_16x16x32_bf16 v[216:219], v[40:43], v[8:11], v[216:219]
  v_mfma_f32_16x16x32_bf16 v[220:223], v[40:43], v[12:15], v[220:223]
  v_mfma_f32_16x16x32_bf16 v[224:227], v[40:43], v[16:19], v[224:227]
  v_mfma_f32_16x16x32_bf16 v[228:231], v[40:43], v[20:23], v[228:231]
  s_waitcnt vmcnt(14)
  buffer_load_dwordx4 v[24:27], v4, s[8:11], s57 offen offset:0
  buffer_load_dwordx4 v[28:31], v4, s[8:11], s57 offen offset:1024
  buffer_load_dwordx4 v[32:35], v4, s[8:11], s57 offen offset:2048
  buffer_load_dwordx4 v[36:39], v4, s[8:11], s57 offen offset:3072
  buffer_load_dwordx4 v[40:43], v5, s[8:11], s57 offen
  s_add_u32 s57, s57, 40960
  v_mfma_f32_16x16x32_bf16 v[152:155], v[60:63], v[44:47], v[152:155]
  v_mfma_f32_16x16x32_bf16 v[156:159], v[60:63], v[48:51], v[156:159]
  v_mfma_f32_16x16x32_bf16 v[160:163], v[60:63], v[52:55], v[160:163]
  v_mfma_f32_16x16x32_bf16 v[164:167], v[60:63], v[56:59], v[164:167]
  v_mfma_f32_16x16x32_bf16 v[168:171], v[64:67], v[44:47], v[168:171]
  v_mfma_f32_16x16x32_bf16 v[172:175], v[64:67], v[48:51], v[172:175]
  v_mfma_f32_16x16x32_bf16 v[176:179], v[64:67], v[52:55], v[176:179]
  v_mfma_f32_16x16x32_bf16 v[180:183], v[64:67], v[56:59], v[180:183]
  v_mfma_f32_16x16x32_bf16 v[184:187], v[68:71], v[44:47], v[184:187]
  v_mfma_f32_16x16x32_bf16 v[188:191], v[68:71], v[48:51], v[188:191]
  v_mfma_f32_16x16x32_bf16 v[192:195], v[68:71], v[52:55], v[192:195]
  v_mfma_f32_16x16x32_bf16 v[196:199], v[68:71], v[56:59], v[196:199]
  v_mfma_f32_16x16x32_bf16 v[200:203], v[72:75], v[44:47], v[200:203]
  v_mfma_f32_16x16x32_bf16 v[204:207], v[72:75], v[48:51], v[204:207]
  v_mfma_f32_16x16x32_bf16 v[208:211], v[72:75], v[52:55], v[208:211]
  v_mfma_f32_16x16x32_bf16 v[212:215], v[72:75], v[56:59], v[212:215]
  v_mfma_f32_16x16x32_bf16 v[216:219], v[76:79], v[44:47], v[216:219]
  v_mfma_f32_16x16x32_bf16 v[220:223], v[76:79], v[48:51], v[220:223]
  v_mfma_f32_16x16x32_bf16 v[224:227], v[76:79], v[52:55], v[224:227]
  v_mfma_f32_16x16x32_bf16 v[228:231], v[76:79], v[56:59], v[228:231]
  s_waitcnt vmcnt(10)
  buffer_load_dwordx4 v[60:63], v4, s[8:11], s57 offen offset:0
  buffer_load_dwordx4 v[64:67], v4, s[8:11], s57 offen offset:1024
  buffer_load_dwordx4 v[68:71], v4, s[8:11], s57 offen offset:2048
  buffer_load_dwordx4 v[72:75], v4, s[8:11], s57 offen offset:3072
  buffer_load_dwordx4 v[76:79], v5, s[8:11], s57 offen
  s_add_u32 s57, s57, 40960
  v_mfma_f32_16x16x32_bf16 v[152:155], v[96:99], v[80:83], v[152:155]
  v_mfma_f32_16x16x32_bf16 v[156:159], v[96:99], v[84:87], v[156:159]
  v_mfma_f32_16x16x32_bf16 v[160:163], v[96:99], v[88:91], v[160:163]
  v_mfma_f32_16x16x32_bf16 v[164:167], v[96:99], v[92:95], v[164:167]
  v_mfma_f32_16x16x32_bf16 v[168:171], v[100:103], v[80:83], v[168:171]
  v_mfma_f32_16x16x32_bf16 v[172:175], v[100:103], v[84:87], v[172:175]
  v_mfma_f32_16x16x32_bf16 v[176:179], v[100:103], v[88:91], v[176:179]
  v_mfma_f32_16x16x32_bf16 v[180:183], v[100:103], v[92:95], v[180:183]
  v_mfma_f32_16x16x32_bf16 v[184:187], v[104:107], v[80:83], v[184:187]
  v_mfma_f32_16x16x32_bf16 v[188:191], v[104:107], v[84:87], v[188:191]
  v_mfma_f32_16x16x32_bf16 v[192:195], v[104:107], v[88:91], v[192:195]
  v_mfma_f32_16x16x32_bf16 v[196:199], v[104:107], v[92:95], v[196:199]
  v_mfma_f32_16x16x32_bf16 v[200:203], v[108:111], v[80:83], v[200:203]
  v_mfma_f32_16x16x32_bf16 v[204:207], v[108:111], v[84:87], v[204:207]
  v_mfma_f32_16x16x32_bf16 v[208:211], v[108:111], v[88:91], v[208:211]
  v_mfma_f32_16x16x32_bf16 v[212:215], v[108:111], v[92:95], v[212:215]
  v_mfma_f32_16x16x32_bf16 v[216:219], v[112:115], v[80:83], v[216:219]
  v_mfma_f32_16x16x32_bf16 v[220:223], v[112:115], v[84:87], v[220:223]
  v_mfma_f32_16x16x32_bf16 v[224:227], v[112:115], v[88:91], v[224:227]
  v_mfma_f32_16x16x32_bf16 v[228:231], v[112:115], v[92:95], v[228:231]
  s_barrier
  ds_read_b128 v[116:119], v7 offset:2048
  ds_read_b128 v[120:123], v7 offset:7168
  ds_read_b128 v[124:127], v7 offset:12288
  ds_read_b128 v[128:131], v7 offset:17408
  s_waitcnt vmcnt(10)
  buffer_load_dwordx4 v[96:99], v4, s[8:11], s56 offen offset:0
  buffer_load_dwordx4 v[80:83], v232, s[8:11], s55 offen
  buffer_load_dwordx4 v[84:87], v233, s[8:11], s55 offen
  buffer_load_dwordx4 v[88:91], v234, s[8:11], s55 offen
  buffer_load_dwordx4 v[92:95], v235, s[8:11], s55 offen
  buffer_load_dwordx4 v[100:103], v4, s[8:11], s56 offen offset:1024
  buffer_load_dwordx4 v[104:107], v4, s[8:11], s56 offen offset:2048
  buffer_load_dwordx4 v[108:111], v4, s[8:11], s56 offen offset:3072
  buffer_load_dwordx4 v[112:115], v5, s[8:11], s56 offen
  s_add_u32 s59, s59, 1
  s_cmp_eq_u32 s59, 12
  s_cselect_b32 s64, s66, s67
  s_cselect_b32 s65, s68, s69
  s_add_u32 s55, s55, s64
  s_add_u32 s56, s56, s65
  s_waitcnt lgkmcnt(0)
  v_mfma_f32_16x16x32_bf16 v[152:155], v[132:135], v[116:119], v[152:155]
  v_mfma_f32_16x16x32_bf16 v[156:159], v[132:135], v[120:123], v[156:159]
  v_mfma_f32_16x16x32_bf16 v[160:163], v[132:135], v[124:127], v[160:163]
  v_mfma_f32_16x16x32_bf16 v[164:167], v[132:135], v[128:131], v[164:167]
  v_mfma_f32_16x16x32_bf16 v[168:171], v[136:139], v[116:119], v[168:171]
  v_mfma_f32_16x16x32_bf16 v[172:175], v[136:139], v[120:123], v[172:175]
  v_mfma_f32_16x16x32_bf16 v[176:179], v[136:139], v[124:127], v[176:179]
  v_mfma_f32_16x16x32_bf16 v[180:183], v[136:139], v[128:131], v[180:183]
  v_mfma_f32_16x16x32_bf16 v[184:187], v[140:143], v[116:119], v[184:187]
  v_mfma_f32_16x16x32_bf16 v[188:191], v[140:143], v[120:123], v[188:191]
  v_mfma_f32_16x16x32_bf16 v[192:195], v[140:143], v[124:127], v[192:195]
  v_mfma_f32_16x16x32_bf16 v[196:199], v[140:143], v[128:131], v[196:199]
  v_mfma_f32_16x16x32_bf16 v[200:203], v[144:147], v[116:119], v[200:203]
  v_mfma_f32_16x16x32_bf16 v[204:207], v[144:147], v[120:123], v[204:207]
  v_mfma_f32_16x16x32_bf16 v[208:211], v[144:147], v[124:127], v[208:211]
  v_mfma_f32_16x16x32_bf16 v[212:215], v[144:147], v[128:131], v[212:215]
  v_mfma_f32_16x16x32_bf16 v[216:219], v[148:151], v[116:119], v[216:219]
  v_mfma_f32_16x16x32_bf16 v[220:223], v[148:151], v[120:123], v[220:223]
  v_mfma_f32_16x16x32_bf16 v[224:227], v[148:151], v[124:127], v[224:227]
  v_mfma_f32_16x16x32_bf16 v[228:231], v[148:151], v[128:131], v[228:231]
  ds_read_b128 v[8:11], v7 offset:3072
  ds_read_b128 v[12:15], v7 offset:8192
  ds_read_b128 v[16:19], v7 offset:13312
  ds_read_b128 v[20:23], v7 offset:18432
  s_waitcnt vmcnt(14)
  buffer_load_dwordx4 v[132:135], v4, s[8:11], s56 offen offset:0
  buffer_load_dwordx4 v[116:119], v232, s[8:11], s55 offen
  buffer_load_dwordx4 v[120:123], v233, s[8:11], s55 offen
  buffer_load_dwordx4 v[124:127], v234, s[8:11], s55 offen
  buffer_load_dwordx4 v[128:131], v235, s[8:11], s55 offen
  buffer_load_dwordx4 v[136:139], v4, s[8:11], s56 offen offset:1024
  buffer_load_dwordx4 v[140:143], v4, s[8:11], s56 offen offset:2048
  buffer_load_dwordx4 v[144:147], v4, s[8:11], s56 offen offset:3072
  buffer_load_dwordx4 v[148:151], v5, s[8:11], s56 offen
  s_add_u32 s59, s59, 1
  s_cmp_eq_u32 s59, 12
  s_cselect_b32 s64, s66, s67
  s_cselect_b32 s65, s68, s69
  s_add_u32 s55, s55, s64
  s_add_u32 s56, s56, s65
  s_waitcnt lgkmcnt(0)
  v_mfma_f32_16x16x32_bf16 v[152:155], v[24:27], v[8:11], v[152:155]
  v_mfma_f32_16x16x32_bf16 v[156:159], v[24:27], v[12:15], v[156:159]
  v_mfma_f32_16x16x32_bf16 v[160:163], v[24:27], v[16:19], v[160:163]
  v_mfma_f32_16x16x32_bf16 v[164:167], v[24:27], v[20:23], v[164:167]
  v_mfma_f32_16x16x32_bf16 v[168:171], v[28:31], v[8:11], v[168:171]
  v_mfma_f32_16x16x32_bf16 v[172:175], v[28:31], v[12:15], v[172:175]
  v_mfma_f32_16x16x32_bf16 v[176:179], v[28:31], v[16:19], v[176:179]
  v_mfma_f32_16x16x32_bf16 v[180:183], v[28:31], v[20:23], v[180:183]
  v_mfma_f32_16x16x32_bf16 v[184:187], v[32:35], v[8:11], v[184:187]
  v_mfma_f32_16x16x32_bf16 v[188:191], v[32:35], v[12:15], v[188:191]
  v_mfma_f32_16x16x32_bf16 v[192:195], v[32:35], v[16:19], v[192:195]
  v_mfma_f32_16x16x32_bf16 v[196:199], v[32:35], v[20:23], v[196:199]
  v_mfma_f32_16x16x32_bf16 v[200:203], v[36:39], v[8:11], v[200:203]
  v_mfma_f32_16x16x32_bf16 v[204:207], v[36:39], v[12:15], v[204:207]
  v_mfma_f32_16x16x32_bf16 v[208:211], v[36:39], v[16:19], v[208:211]
  v_mfma_f32_16x16x32_bf16 v[212:215], v[36:39], v[20:23], v[212:215]
  v_mfma_f32_16x16x32_bf16 v[216:219], v[40:43], v[8:11], v[216:219]
  v_mfma_f32_16x16x32_bf16 v[220:223], v[40:43], v[12:15], v[220:223]
  v_mfma_f32_16x16x32_bf16 v[224:227], v[40:43], v[16:19], v[224:227]
  v_mfma_f32_16x16x32_bf16 v[228:231], v[40:43], v[20:23], v[228:231]
  ds_read_b128 v[44:47], v7 offset:4096
  ds_read_b128 v[48:51], v7 offset:9216
  ds_read_b128 v[52:55], v7 offset:14336
  ds_read_b128 v[56:59], v7 offset:19456
  s_waitcnt vmcnt(18)
  buffer_load_dwordx4 v[24:27], v4, s[8:11], s56 offen offset:0
  buffer_load_dwordx4 v[8:11], v232, s[8:11], s55 offen
  buffer_load_dwordx4 v[12:15], v233, s[8:11], s55 offen
  buffer_load_dwordx4 v[16:19], v234, s[8:11], s55 offen
  buffer_load_dwordx4 v[20:23], v235, s[8:11], s55 offen
  buffer_load_dwordx4 v[28:31], v4, s[8:11], s56 offen offset:1024
  buffer_load_dwordx4 v[32:35], v4, s[8:11], s56 offen offset:2048
  buffer_load_dwordx4 v[36:39], v4, s[8:11], s56 offen offset:3072
  buffer_load_dwordx4 v[40:43], v5, s[8:11], s56 offen
  s_add_u32 s59, s59, 1
  s_cmp_eq_u32 s59, 12
  s_cselect_b32 s64, s66, s67
  s_cselect_b32 s65, s68, s69
  s_add_u32 s55, s55, s64
  s_add_u32 s56, s56, s65
  s_waitcnt lgkmcnt(0)
  v_mfma_f32_16x16x32_bf16 v[152:155], v[60:63], v[44:47], v[152:155]
  v_mfma_f32_16x16x32_bf16 v[156:159], v[60:63], v[48:51], v[156:159]
  v_mfma_f32_16x16x32_bf16 v[160:163], v[60:63], v[52:55], v[160:163]
  v_mfma_f32_16x16x32_bf16 v[164:167], v[60:63], v[56:59], v[164:167]
  v_mfma_f32_16x16x32_bf16 v[168:171], v[64:67], v[44:47], v[168:171]
  v_mfma_f32_16x16x32_bf16 v[172:175], v[64:67], v[48:51], v[172:175]
  v_mfma_f32_16x16x32_bf16 v[176:179], v[64:67], v[52:55], v[176:179]
  v_mfma_f32_16x16x32_bf16 v[180:183], v[64:67], v[56:59], v[180:183]
  v_mfma_f32_16x16x32_bf16 v[184:187], v[68:71], v[44:47], v[184:187]
  v_mfma_f32_16x16x32_bf16 v[188:191], v[68:71], v[48:51], v[188:191]
  v_mfma_f32_16x16x32_bf16 v[192:195], v[68:71], v[52:55], v[192:195]
  v_mfma_f32_16x16x32_bf16 v[196:199], v[68:71], v[56:59], v[196:199]
  v_mfma_f32_16x16x32_bf16 v[200:203], v[72:75], v[44:47], v[200:203]
  v_mfma_f32_16x16x32_bf16 v[204:207], v[72:75], v[48:51], v[204:207]
  v_mfma_f32_16x16x32_bf16 v[208:211], v[72:75], v[52:55], v[208:211]
  v_mfma_f32_16x16x32_bf16 v[212:215], v[72:75], v[56:59], v[212:215]
  v_mfma_f32_16x16x32_bf16 v[216:219], v[76:79], v[44:47], v[216:219]
  v_mfma_f32_16x16x32_bf16 v[220:223], v[76:79], v[48:51], v[220:223]
  v_mfma_f32_16x16x32_bf16 v[224:227], v[76:79], v[52:55], v[224:227]
  v_mfma_f32_16x16x32_bf16 v[228:231], v[76:79], v[56:59], v[228:231]
  s_waitcnt vmcnt(18)
  v_mfma_f32_16x16x32_bf16 v[152:155], v[96:99], v[80:83], v[152:155]
  v_mfma_f32_16x16x32_bf16 v[156:159], v[96:99], v[84:87], v[156:159]
  v_mfma_f32_16x16x32_bf16 v[160:163], v[96:99], v[88:91], v[160:163]
  v_mfma_f32_16x16x32_bf16 v[164:167], v[96:99], v[92:95], v[164:167]
  v_mfma_f32_16x16x32_bf16 v[168:171], v[100:103], v[80:83], v[168:171]
  v_mfma_f32_16x16x32_bf16 v[172:175], v[100:103], v[84:87], v[172:175]
  v_mfma_f32_16x16x32_bf16 v[176:179], v[100:103], v[88:91], v[176:179]
  v_mfma_f32_16x16x32_bf16 v[180:183], v[100:103], v[92:95], v[180:183]
  v_mfma_f32_16x16x32_bf16 v[184:187], v[104:107], v[80:83], v[184:187]
  v_mfma_f32_16x16x32_bf16 v[188:191], v[104:107], v[84:87], v[188:191]
  v_mfma_f32_16x16x32_bf16 v[192:195], v[104:107], v[88:91], v[192:195]
  v_mfma_f32_16x16x32_bf16 v[196:199], v[104:107], v[92:95], v[196:199]
  v_mfma_f32_16x16x32_bf16 v[200:203], v[108:111], v[80:83], v[200:203]
  v_mfma_f32_16x16x32_bf16 v[204:207], v[108:111], v[84:87], v[204:207]
  v_mfma_f32_16x16x32_bf16 v[208:211], v[108:111], v[88:91], v[208:211]
  v_mfma_f32_16x16x32_bf16 v[212:215], v[108:111], v[92:95], v[212:215]
  v_mfma_f32_16x16x32_bf16 v[216:219], v[112:115], v[80:83], v[216:219]
  v_mfma_f32_16x16x32_bf16 v[220:223], v[112:115], v[84:87], v[220:223]
  v_mfma_f32_16x16x32_bf16 v[224:227], v[112:115], v[88:91], v[224:227]
  v_mfma_f32_16x16x32_bf16 v[228:231], v[112:115], v[92:95], v[228:231]
  s_waitcnt vmcnt(9)
  v_mfma_f32_16x16x32_bf16 v[152:155], v[132:135], v[116:119], v[152:155]
  v_mfma_f32_16x16x32_bf16 v[156:159], v[132:135], v[120:123], v[156:159]
  v_mfma_f32_16x16x32_bf16 v[160:163], v[132:135], v[124:127], v[160:163]
  v_mfma_f32_16x16x32_bf16 v[164:167], v[132:135], v[128:131], v[164:167]
  v_mfma_f32_16x16x32_bf16 v[168:171], v[136:139], v[116:119], v[168:171]
  v_mfma_f32_16x16x32_bf16 v[172:175], v[136:139], v[120:123], v[172:175]
  v_mfma_f32_16x16x32_bf16 v[176:179], v[136:139], v[124:127], v[176:179]
  v_mfma_f32_16x16x32_bf16 v[180:183], v[136:139], v[128:131], v[180:183]
  v_mfma_f32_16x16x32_bf16 v[184:187], v[140:143], v[116:119], v[184:187]
  v_mfma_f32_16x16x32_bf16 v[188:191], v[140:143], v[120:123], v[188:191]
  v_mfma_f32_16x16x32_bf16 v[192:195], v[140:143], v[124:127], v[192:195]
  v_mfma_f32_16x16x32_bf16 v[196:199], v[140:143], v[128:131], v[196:199]
  v_mfma_f32_16x16x32_bf16 v[200:203], v[144:147], v[116:119], v[200:203]
  v_mfma_f32_16x16x32_bf16 v[204:207], v[144:147], v[120:123], v[204:207]
  v_mfma_f32_16x16x32_bf16 v[208:211], v[144:147], v[124:127], v[208:211]
  v_mfma_f32_16x16x32_bf16 v[212:215], v[144:147], v[128:131], v[212:215]
  v_mfma_f32_16x16x32_bf16 v[216:219], v[148:151], v[116:119], v[216:219]
  v_mfma_f32_16x16x32_bf16 v[220:223], v[148:151], v[120:123], v[220:223]
  v_mfma_f32_16x16x32_bf16 v[224:227], v[148:151], v[124:127], v[224:227]
  v_mfma_f32_16x16x32_bf16 v[228:231], v[148:151], v[128:131], v[228:231]
  s_waitcnt vmcnt(0)
  v_mfma_f32_16x16x32_bf16 v[152:155], v[24:27], v[8:11], v[152:155]
  v_mfma_f32_16x16x32_bf16 v[156:159], v[24:27], v[12:15], v[156:159]
  v_mfma_f32_16x16x32_bf16 v[160:163], v[24:27], v[16:19], v[160:163]
  v_mfma_f32_16x16x32_bf16 v[164:167], v[24:27], v[20:23], v[164:167]
  v_mfma_f32_16x16x32_bf16 v[168:171], v[28:31], v[8:11], v[168:171]
  v_mfma_f32_16x16x32_bf16 v[172:175], v[28:31], v[12:15], v[172:175]
  v_mfma_f32_16x16x32_bf16 v[176:179], v[28:31], v[16:19], v[176:179]
  v_mfma_f32_16x16x32_bf16 v[180:183], v[28:31], v[20:23], v[180:183]
  v_mfma_f32_16x16x32_bf16 v[184:187], v[32:35], v[8:11], v[184:187]
  v_mfma_f32_16x16x32_bf16 v[188:191], v[32:35], v[12:15], v[188:191]
  v_mfma_f32_16x16x32_bf16 v[192:195], v[32:35], v[16:19], v[192:195]
  v_mfma_f32_16x16x32_bf16 v[196:199], v[32:35], v[20:23], v[196:199]
  v_mfma_f32_16x16x32_bf16 v[200:203], v[36:39], v[8:11], v[200:203]
  v_mfma_f32_16x16x32_bf16 v[204:207], v[36:39], v[12:15], v[204:207]
  v_mfma_f32_16x16x32_bf16 v[208:211], v[36:39], v[16:19], v[208:211]
  v_mfma_f32_16x16x32_bf16 v[212:215], v[36:39], v[20:23], v[212:215]
  v_mfma_f32_16x16x32_bf16 v[216:219], v[40:43], v[8:11], v[216:219]
  v_mfma_f32_16x16x32_bf16 v[220:223], v[40:43], v[12:15], v[220:223]
  v_mfma_f32_16x16x32_bf16 v[224:227], v[40:43], v[16:19], v[224:227]
  v_mfma_f32_16x16x32_bf16 v[228:231], v[40:43], v[20:23], v[228:231]
  v_sub_f32 v236, 1.0, v236
  v_cvt_pk_bf16_f32 v236, v236, v236
  v_lshlrev_b32 v236, 16, v236
  s_barrier
  s_cmp_lg_u32 s35, 0
  s_cbranch_scc1 L_s2_fw0
  ds_write_b128 v4, v[156:159] offset:15360
  ds_write_b128 v4, v[172:175] offset:16384
  ds_write_b128 v4, v[188:191] offset:17408
  ds_write_b128 v4, v[204:207] offset:18432
  ds_write_b128 v4, v[220:223] offset:19456
  ds_write_b128 v4, v[160:163] offset:30720
  ds_write_b128 v4, v[176:179] offset:31744
  ds_write_b128 v4, v[192:195] offset:32768
  ds_write_b128 v4, v[208:211] offset:33792
  ds_write_b128 v4, v[224:227] offset:34816
  ds_write_b128 v4, v[164:167] offset:46080
  ds_write_b128 v4, v[180:183] offset:47104
  ds_write_b128 v4, v[196:199] offset:48128
  ds_write_b128 v4, v[212:215] offset:49152
  ds_write_b128 v4, v[228:231] offset:50176
  v_lshlrev_b32 v8, 16, v238
  v_and_b32 v9, 0xffff0000, v238
  v_lshlrev_b32 v10, 16, v239
  v_and_b32 v11, 0xffff0000, v239
  v_pk_fma_f32 v[16:17], v[8:9], v[236:237], v[152:153] op_sel_hi:[1,0,1]
  v_pk_fma_f32 v[18:19], v[10:11], v[236:237], v[154:155] op_sel_hi:[1,0,1]
  v_lshlrev_b32 v8, 16, v240
  v_and_b32 v9, 0xffff0000, v240
  v_lshlrev_b32 v10, 16, v241
  v_and_b32 v11, 0xffff0000, v241
  v_pk_fma_f32 v[20:21], v[8:9], v[236:237], v[168:169] op_sel_hi:[1,0,1]
  v_pk_fma_f32 v[22:23], v[10:11], v[236:237], v[170:171] op_sel_hi:[1,0,1]
  v_lshlrev_b32 v8, 16, v242
  v_and_b32 v9, 0xffff0000, v242
  v_lshlrev_b32 v10, 16, v243
  v_and_b32 v11, 0xffff0000, v243
  v_pk_fma_f32 v[24:25], v[8:9], v[236:237], v[184:185] op_sel_hi:[1,0,1]
  v_pk_fma_f32 v[26:27], v[10:11], v[236:237], v[186:187] op_sel_hi:[1,0,1]
  v_lshlrev_b32 v8, 16, v244
  v_and_b32 v9, 0xffff0000, v244
  v_lshlrev_b32 v10, 16, v245
  v_and_b32 v11, 0xffff0000, v245
  v_pk_fma_f32 v[28:29], v[8:9], v[236:237], v[200:201] op_sel_hi:[1,0,1]
  v_pk_fma_f32 v[30:31], v[10:11], v[236:237], v[202:203] op_sel_hi:[1,0,1]
  v_lshlrev_b32 v8, 16, v246
  v_and_b32 v9, 0xffff0000, v246
  v_lshlrev_b32 v10, 16, v247
  v_and_b32 v11, 0xffff0000, v247
  v_pk_fma_f32 v[32:33], v[8:9], v[236:237], v[216:217] op_sel_hi:[1,0,1]
  v_pk_fma_f32 v[34:35], v[10:11], v[236:237], v[218:219] op_sel_hi:[1,0,1]
L_s2_fw0:
  s_cmp_lg_u32 s35, 1
  s_cbranch_scc1 L_s2_fw1
  ds_write_b128 v4, v[152:155] offset:0
  ds_write_b128 v4, v[168:171] offset:1024
  ds_write_b128 v4, v[184:187] offset:2048
  ds_write_b128 v4, v[200:203] offset:3072
  ds_write_b128 v4, v[216:219] offset:4096
  ds_write_b128 v4, v[160:163] offset:35840
  ds_write_b128 v4, v[176:179] offset:36864
  ds_write_b128 v4, v[192:195] offset:37888
  ds_write_b128 v4, v[208:211] offset:38912
  ds_write_b128 v4, v[224:227] offset:39936
  ds_write_b128 v4, v[164:167] offset:51200
  ds_write_b128 v4, v[180:183] offset:52224
  ds_write_b128 v4, v[196:199] offset:53248
  ds_write_b128 v4, v[212:215] offset:54272
  ds_write_b128 v4, v[228:231] offset:55296
  v_lshlrev_b32 v8, 16, v238
  v_and_b32 v9, 0xffff0000, v238
  v_lshlrev_b32 v10, 16, v239
  v_and_b32 v11, 0xffff0000, v239
  v_pk_fma_f32 v[16:17], v[8:9], v[236:237], v[156:157] op_sel_hi:[1,0,1]
  v_pk_fma_f32 v[18:19], v[10:11], v[236:237], v[158:159] op_sel_hi:[1,0,1]
  v_lshlrev_b32 v8, 16, v240
  v_and_b32 v9, 0xffff0000, v240
  v_lshlrev_b32 v10, 16, v241
  v_and_b32 v11, 0xffff0000, v241
  v_pk_fma_f32 v[20:21], v[8:9], v[236:237], v[172:173] op_sel_hi:[1,0,1]
  v_pk_fma_f32 v[22:23], v[10:11], v[236:237], v[174:175] op_sel_hi:[1,0,1]
  v_lshlrev_b32 v8, 16, v242
  v_and_b32 v9, 0xffff0000, v242
  v_lshlrev_b32 v10, 16, v243
  v_and_b32 v11, 0xffff0000, v243
  v_pk_fma_f32 v[24:25], v[8:9], v[236:237], v[188:189] op_sel_hi:[1,0,1]
  v_pk_fma_f32 v[26:27], v[10:11], v[236:237], v[190:191] op_sel_hi:[1,0,1]
  v_lshlrev_b32 v8, 16, v244
  v_and_b32 v9, 0xffff0000, v244
  v_lshlrev_b32 v10, 16, v245
  v_and_b32 v11, 0xffff0000, v245
  v_pk_fma_f32 v[28:29], v[8:9], v[236:237], v[204:205] op_sel_hi:[1,0,1]
  v_pk_fma_f32 v[30:31], v[10:11], v[236:237], v[206:207] op_sel_hi:[1,0,1]
  v_lshlrev_b32 v8, 16, v246
  v_and_b32 v9, 0xffff0000, v246
  v_lshlrev_b32 v10, 16, v247
  v_and_b32 v11, 0xffff0000, v247
  v_pk_fma_f32 v[32:33], v[8:9], v[236:237], v[220:221] op_sel_hi:[1,0,1]
  v_pk_fma_f32 v[34:35], v[10:11], v[236:237], v[222:223] op_sel_hi:[1,0,1]
L_s2_fw1:
  s_cmp_lg_u32 s35, 2
  s_cbranch_scc1 L_s2_fw2
  ds_write_b128 v4, v[152:155] offset:5120
  ds_write_b128 v4, v[168:171] offset:6144
  ds_write_b128 v4, v[184:187] offset:7168
  ds_write_b128 v4, v[200:203] offset:8192
  ds_write_b128 v4, v[216:219] offset:9216
  ds_write_b128 v4, v[156:159] offset:20480
  ds_write_b128 v4, v[172:175] offset:21504
  ds_write_b128 v4, v[188:191] offset:22528
  ds_write_b128 v4, v[204:207] offset:23552
  ds_write_b128 v4, v[220:223] offset:24576
  ds_write_b128 v4, v[164:167] offset:56320
  ds_write_b128 v4, v[180:183] offset:57344
  ds_write_b128 v4, v[196:199] offset:58368
  ds_write_b128 v4, v[212:215] offset:59392
  ds_write_b128 v4, v[228:231] offset:60416
  v_lshlrev_b32 v8, 16, v238
  v_and_b32 v9, 0xffff0000, v238
  v_lshlrev_b32 v10, 16, v239
  v_and_b32 v11, 0xffff0000, v239
  v_pk_fma_f32 v[16:17], v[8:9], v[236:237], v[160:161] op_sel_hi:[1,0,1]
  v_pk_fma_f32 v[18:19], v[10:11], v[236:237], v[162:163] op_sel_hi:[1,0,1]
  v_lshlrev_b32 v8, 16, v240
  v_and_b32 v9, 0xffff0000, v240
  v_lshlrev_b32 v10, 16, v241
  v_and_b32 v11, 0xffff0000, v241
  v_pk_fma_f32 v[20:21], v[8:9], v[236:237], v[176:177] op_sel_hi:[1,0,1]
  v_pk_fma_f32 v[22:23], v[10:11], v[236:237], v[178:179] op_sel_hi:[1,0,1]
  v_lshlrev_b32 v8, 16, v242
  v_and_b32 v9, 0xffff0000, v242
  v_lshlrev_b32 v10, 16, v243
  v_and_b32 v11, 0xffff0000, v243
  v_pk_fma_f32 v[24:25], v[8:9], v[236:237], v[192:193] op_sel_hi:[1,0,1]
  v_pk_fma_f32 v[26:27], v[10:11], v[236:237], v[194:195] op_sel_hi:[1,0,1]
  v_lshlrev_b32 v8, 16, v244
  v_and_b32 v9, 0xffff0000, v244
  v_lshlrev_b32 v10, 16, v245
  v_and_b32 v11, 0xffff0000, v245
  v_pk_fma_f32 v[28:29], v[8:9], v[236:237], v[208:209] op_sel_hi:[1,0,1]
  v_pk_fma_f32 v[30:31], v[10:11], v[236:237], v[210:211] op_sel_hi:[1,0,1]
  v_lshlrev_b32 v8, 16, v246
  v_and_b32 v9, 0xffff0000, v246
  v_lshlrev_b32 v10, 16, v247
  v_and_b32 v11, 0xffff0000, v247
  v_pk_fma_f32 v[32:33], v[8:9], v[236:237], v[224:225] op_sel_hi:[1,0,1]
  v_pk_fma_f32 v[34:35], v[10:11], v[236:237], v[226:227] op_sel_hi:[1,0,1]
L_s2_fw2:
  s_cmp_lg_u32 s35, 3
  s_cbranch_scc1 L_s2_fw3
  ds_write_b128 v4, v[152:155] offset:10240
  ds_write_b128 v4, v[168:171] offset:11264
  ds_write_b128 v4, v[184:187] offset:12288
  ds_write_b128 v4, v[200:203] offset:13312
  ds_write_b128 v4, v[216:219] offset:14336
  ds_write_b128 v4, v[156:159] offset:25600
  ds_write_b128 v4, v[172:175] offset:26624
  ds_write_b128 v4, v[188:191] offset:27648
  ds_write_b128 v4, v[204:207] offset:28672
  ds_write_b128 v4, v[220:223] offset:29696
  ds_write_b128 v4, v[160:163] offset:40960
  ds_write_b128 v4, v[176:179] offset:41984
  ds_write_b128 v4, v[192:195] offset:43008
  ds_write_b128 v4, v[208:211] offset:44032
  ds_write_b128 v4, v[224:227] offset:45056
  v_lshlrev_b32 v8, 16, v238
  v_and_b32 v9, 0xffff0000, v238
  v_lshlrev_b32 v10, 16, v239
  v_and_b32 v11, 0xffff0000, v239
  v_pk_fma_f32 v[16:17], v[8:9], v[236:237], v[164:165] op_sel_hi:[1,0,1]
  v_pk_fma_f32 v[18:19], v[10:11], v[236:237], v[166:167] op_sel_hi:[1,0,1]
  v_lshlrev_b32 v8, 16, v240
  v_and_b32 v9, 0xffff0000, v240
  v_lshlrev_b32 v10, 16, v241
  v_and_b32 v11, 0xffff0000, v241
  v_pk_fma_f32 v[20:21], v[8:9], v[236:237], v[180:181] op_sel_hi:[1,0,1]
  v_pk_fma_f32 v[22:23], v[10:11], v[236:237], v[182:183] op_sel_hi:[1,0,1]
  v_lshlrev_b32 v8, 16, v242
  v_and_b32 v9, 0xffff0000, v242
  v_lshlrev_b32 v10, 16, v243
  v_and_b32 v11, 0xffff0000, v243
  v_pk_fma_f32 v[24:25], v[8:9], v[236:237], v[196:197] op_sel_hi:[1,0,1]
  v_pk_fma_f32 v[26:27], v[10:11], v[236:237], v[198:199] op_sel_hi:[1,0,1]
  v_lshlrev_b32 v8, 16, v244
  v_and_b32 v9, 0xffff0000, v244
  v_lshlrev_b32 v10, 16, v245
  v_and_b32 v11, 0xffff0000, v245
  v_pk_fma_f32 v[28:29], v[8:9], v[236:237], v[212:213] op_sel_hi:[1,0,1]
  v_pk_fma_f32 v[30:31], v[10:11], v[236:237], v[214:215] op_sel_hi:[1,0,1]
  v_lshlrev_b32 v8, 16, v246
  v_and_b32 v9, 0xffff0000, v246
  v_lshlrev_b32 v10, 16, v247
  v_and_b32 v11, 0xffff0000, v247
  v_pk_fma_f32 v[32:33], v[8:9], v[236:237], v[228:229] op_sel_hi:[1,0,1]
  v_pk_fma_f32 v[34:35], v[10:11], v[236:237], v[230:231] op_sel_hi:[1,0,1]
L_s2_fw3:
  s_mul_i32 s61, s35, 15360
  v_add_u32 v7, s61, v4
  s_waitcnt lgkmcnt(0)
  s_barrier
  ds_read_b128 v[40:43], v7 offset:0
  ds_read_b128 v[44:47], v7 offset:1024
  ds_read_b128 v[48:51], v7 offset:2048
  ds_read_b128 v[52:55], v7 offset:3072
  ds_read_b128 v[56:59], v7 offset:4096
  ds_read_b128 v[60:63], v7 offset:5120
  ds_read_b128 v[64:67], v7 offset:6144
  ds_read_b128 v[68:71], v7 offset:7168
  ds_read_b128 v[72:75], v7 offset:8192
  ds_read_b128 v[76:79], v7 offset:9216
  ds_read_b128 v[80:83], v7 offset:10240
  ds_read_b128 v[84:87], v7 offset:11264
  ds_read_b128 v[88:91], v7 offset:12288
  ds_read_b128 v[92:95], v7 offset:13312
  ds_read_b128 v[96:99], v7 offset:14336
  v_mul_u32_u24 v6, 1280, v6
  v_and_b32 v8, 1, v3
  v_lshl_add_u32 v8, v8, 5, v6
  v_lshrrev_b32 v9, 1, v3
  v_lshl_add_u32 v8, v9, 4, v8
  v_lshl_add_u32 v9, v3, 3, v6
  s_waitcnt lgkmcnt(10)
  v_pk_add_f32 v[16:17], v[16:17], v[40:41]
  v_pk_add_f32 v[18:19], v[18:19], v[42:43]
  v_pk_add_f32 v[20:21], v[20:21], v[44:45]
  v_pk_add_f32 v[22:23], v[22:23], v[46:47]
  v_pk_add_f32 v[24:25], v[24:25], v[48:49]
  v_pk_add_f32 v[26:27], v[26:27], v[50:51]
  v_pk_add_f32 v[28:29], v[28:29], v[52:53]
  v_pk_add_f32 v[30:31], v[30:31], v[54:55]
  v_pk_add_f32 v[32:33], v[32:33], v[56:57]
  v_pk_add_f32 v[34:35], v[34:35], v[58:59]
  s_waitcnt lgkmcnt(5)
  v_pk_add_f32 v[16:17], v[16:17], v[60:61]
  v_pk_add_f32 v[18:19], v[18:19], v[62:63]
  v_pk_add_f32 v[20:21], v[20:21], v[64:65]
  v_pk_add_f32 v[22:23], v[22:23], v[66:67]
  v_pk_add_f32 v[24:25], v[24:25], v[68:69]
  v_pk_add_f32 v[26:27], v[26:27], v[70:71]
  v_pk_add_f32 v[28:29], v[28:29], v[72:73]
  v_pk_add_f32 v[30:31], v[30:31], v[74:75]
  v_pk_add_f32 v[32:33], v[32:33], v[76:77]
  v_pk_add_f32 v[34:35], v[34:35], v[78:79]
  s_waitcnt lgkmcnt(0)
  v_pk_add_f32 v[16:17], v[16:17], v[80:81]
  v_pk_add_f32 v[18:19], v[18:19], v[82:83]
  v_pk_add_f32 v[20:21], v[20:21], v[84:85]
  v_pk_add_f32 v[22:23], v[22:23], v[86:87]
  v_pk_add_f32 v[24:25], v[24:25], v[88:89]
  v_pk_add_f32 v[26:27], v[26:27], v[90:91]
  v_pk_add_f32 v[28:29], v[28:29], v[92:93]
  v_pk_add_f32 v[30:31], v[30:31], v[94:95]
  v_pk_add_f32 v[32:33], v[32:33], v[96:97]
  v_pk_add_f32 v[34:35], v[34:35], v[98:99]
  v_cvt_pk_bf16_f32 v16, v16, v17
  v_cvt_pk_bf16_f32 v17, v18, v19
  v_cvt_pk_bf16_f32 v18, v20, v21
  v_cvt_pk_bf16_f32 v19, v22, v23
  v_cvt_pk_bf16_f32 v24, v24, v25
  v_cvt_pk_bf16_f32 v25, v26, v27
  v_cvt_pk_bf16_f32 v26, v28, v29
  v_cvt_pk_bf16_f32 v27, v30, v31
  v_cvt_pk_bf16_f32 v32, v32, v33
  v_cvt_pk_bf16_f32 v33, v34, v35
  v_permlane16_swap_b32 v16, v18
  v_permlane16_swap_b32 v17, v19
  buffer_store_dwordx4 v[16:19], v8, s[24:27], s58 offen offset:0
  v_permlane16_swap_b32 v24, v26
  v_permlane16_swap_b32 v25, v27
  buffer_store_dwordx4 v[24:27], v8, s[24:27], s58 offen offset:64
  buffer_store_dwordx2 v[32:33], v9, s[24:27], s58 offen offset:128
  s_endpgm
L_s2_awave:
  s_setprio 2
  s_sub_u32 s58, s35, 4
  s_mul_i32 s54, s58, 20480
  s_mul_i32 s60, s34, 160
  s_mul_i32 s61, s58, 40
  s_add_u32 s60, s60, s61
  s_lshl_b32 s60, s60, 7
  s_add_u32 s60, s60, 0x600000
  v_add_u32 v5, s32, v2
  v_lshlrev_b32 v5, 2, v5
  v_add_u32 v5, 0xa10000, v5
  s_cmp_ge_u32 s2, 32
  s_cbranch_scc1 L_s2_nored
  s_cmp_eq_u32 s35, 4
  s_cbranch_scc1 L_s2_dored
  s_barrier
  s_branch L_s2_nored
L_s2_dored:
  s_setprio 3
  v_mul_u32_u24 v8, 171, v1
  v_lshrrev_b32 v8, 9, v8
  v_mul_u32_u24 v9, 3, v8
  v_sub_u32 v9, v1, v9
  v_mul_u32_u24 v6, 80, v8
  v_lshl_add_u32 v6, v9, 5, v6
  v_add_u32 v7, 16, v6
  v_mov_b32 v10, 0x7000000
  v_cmp_eq_u32 vcc, 2, v9
  s_mul_i32 s12, s2, 1680
  s_add_u32 s12, s12, 0x900000
  s_nop 0
  v_cndmask_b32 v7, v7, v10, vcc
  v_cmp_gt_u32 vcc, 63, v1
  s_and_saveexec_b64 s[16:17], vcc
  buffer_load_dwordx4 v[16:19], v6, s[8:11], s12 offen
  buffer_load_dwordx4 v[20:23], v7, s[8:11], s12 offen
  s_add_u32 s12, s12, 53760
  buffer_load_dwordx4 v[24:27], v6, s[8:11], s12 offen
  buffer_load_dwordx4 v[28:31], v7, s[8:11], s12 offen
  s_add_u32 s12, s12, 53760
  buffer_load_dwordx4 v[32:35], v6, s[8:11], s12 offen
  buffer_load_dwordx4 v[36:39], v7, s[8:11], s12 offen
  s_add_u32 s12, s12, 53760
  buffer_load_dwordx4 v[40:43], v6, s[8:11], s12 offen
  buffer_load_dwordx4 v[44:47], v7, s[8:11], s12 offen
  s_add_u32 s12, s12, 53760
  buffer_load_dwordx4 v[48:51], v6, s[8:11], s12 offen
  buffer_load_dwordx4 v[52:55], v7, s[8:11], s12 offen
  s_add_u32 s12, s12, 53760
  buffer_load_dwordx4 v[56:59], v6, s[8:11], s12 offen
  buffer_load_dwordx4 v[60:63], v7, s[8:11], s12 offen
  s_add_u32 s12, s12, 53760
  buffer_load_dwordx4 v[64:67], v6, s[8:11], s12 offen
  buffer_load_dwordx4 v[68:71], v7, s[8:11], s12 offen
  s_add_u32 s12, s12, 53760
  buffer_load_dwordx4 v[72:75], v6, s[8:11], s12 offen
  buffer_load_dwordx4 v[76:79], v7, s[8:11], s12 offen
  s_add_u32 s12, s12, 53760
  buffer_load_dwordx4 v[80:83], v6, s[8:11], s12 offen
  buffer_load_dwordx4 v[84:87], v7, s[8:11], s12 offen
  s_add_u32 s12, s12, 53760
  buffer_load_dwordx4 v[88:91], v6, s[8:11], s12 offen
  buffer_load_dwordx4 v[92:95], v7, s[8:11], s12 offen
  s_add_u32 s12, s12, 53760
  buffer_load_dwordx4 v[96:99], v6, s[8:11], s12 offen
  buffer_load_dwordx4 v[100:103], v7, s[8:11], s12 offen
  s_add_u32 s12, s12, 53760
  buffer_load_dwordx4 v[104:107], v6, s[8:11], s12 offen
  buffer_load_dwordx4 v[108:111], v7, s[8:11], s12 offen
  s_add_u32 s12, s12, 53760
  buffer_load_dwordx4 v[112:115], v6, s[8:11], s12 offen
  buffer_load_dwordx4 v[116:119], v7, s[8:11], s12 offen
  s_add_u32 s12, s12, 53760
  buffer_load_dwordx4 v[120:123], v6, s[8:11], s12 offen
  buffer_load_dwordx4 v[124:127], v7, s[8:11], s12 offen
  s_add_u32 s12, s12, 53760
  buffer_load_dwordx4 v[128:131], v6, s[8:11], s12 offen
  buffer_load_dwordx4 v[132:135], v7, s[8:11], s12 offen
  s_add_u32 s12, s12, 53760
  buffer_load_dwordx4 v[136:139], v6, s[8:11], s12 offen
  buffer_load_dwordx4 v[140:143], v7, s[8:11], s12 offen
  s_and_b32 s13, s2, 3
  s_lshl_b32 s13, s13, 2
  s_sub_u32 s14, s13, 16
  v_add_u32 v10, s14, v8
  v_and_b32 v10, 15, v10
  v_add_u32 v10, 48, v10
  v_cmp_gt_u32 vcc, 16, v8
  s_mul_i32 s12, s2, 1536
  s_add_u32 s12, s12, 0xa00000
  v_cndmask_b32 v10, v10, v8, vcc
  v_lshlrev_b32 v10, 4, v10
  v_lshl_add_u32 v10, v9, 8, v10
  s_waitcnt vmcnt(28)
  v_pk_add_f32 v[16:17], v[16:17], v[24:25]
  v_pk_add_f32 v[18:19], v[18:19], v[26:27]
  v_pk_add_f32 v[20:21], v[20:21], v[28:29]
  v_pk_add_f32 v[22:23], v[22:23], v[30:31]
  s_waitcnt vmcnt(26)
  v_pk_add_f32 v[16:17], v[16:17], v[32:33]
  v_pk_add_f32 v[18:19], v[18:19], v[34:35]
  v_pk_add_f32 v[20:21], v[20:21], v[36:37]
  v_pk_add_f32 v[22:23], v[22:23], v[38:39]
  s_waitcnt vmcnt(24)
  v_pk_add_f32 v[16:17], v[16:17], v[40:41]
  v_pk_add_f32 v[18:19], v[18:19], v[42:43]
  v_pk_add_f32 v[20:21], v[20:21], v[44:45]
  v_pk_add_f32 v[22:23], v[22:23], v[46:47]
  s_waitcnt vmcnt(22)
  v_pk_add_f32 v[16:17], v[16:17], v[48:49]
  v_pk_add_f32 v[18:19], v[18:19], v[50:51]
  v_pk_add_f32 v[20:21], v[20:21], v[52:53]
  v_pk_add_f32 v[22:23], v[22:23], v[54:55]
  s_waitcnt vmcnt(20)
  v_pk_add_f32 v[16:17], v[16:17], v[56:57]
  v_pk_add_f32 v[18:19], v[18:19], v[58:59]
  v_pk_add_f32 v[20:21], v[20:21], v[60:61]
  v_pk_add_f32 v[22:23], v[22:23], v[62:63]
  s_waitcnt vmcnt(18)
  v_pk_add_f32 v[16:17], v[16:17], v[64:65]
  v_pk_add_f32 v[18:19], v[18:19], v[66:67]
  v_pk_add_f32 v[20:21], v[20:21], v[68:69]
  v_pk_add_f32 v[22:23], v[22:23], v[70:71]
  s_waitcnt vmcnt(16)
  v_pk_add_f32 v[16:17], v[16:17], v[72:73]
  v_pk_add_f32 v[18:19], v[18:19], v[74:75]
  v_pk_add_f32 v[20:21], v[20:21], v[76:77]
  v_pk_add_f32 v[22:23], v[22:23], v[78:79]
  s_waitcnt vmcnt(14)
  v_pk_add_f32 v[16:17], v[16:17], v[80:81]
  v_pk_add_f32 v[18:19], v[18:19], v[82:83]
  v_pk_add_f32 v[20:21], v[20:21], v[84:85]
  v_pk_add_f32 v[22:23], v[22:23], v[86:87]
  s_waitcnt vmcnt(12)
  v_pk_add_f32 v[16:17], v[16:17], v[88:89]
  v_pk_add_f32 v[18:19], v[18:19], v[90:91]
  v_pk_add_f32 v[20:21], v[20:21], v[92:93]
  v_pk_add_f32 v[22:23], v[22:23], v[94:95]
  s_waitcnt vmcnt(10)
  v_pk_add_f32 v[16:17], v[16:17], v[96:97]
  v_pk_add_f32 v[18:19], v[18:19], v[98:99]
  v_pk_add_f32 v[20:21], v[20:21], v[100:101]
  v_pk_add_f32 v[22:23], v[22:23], v[102:103]
  s_waitcnt vmcnt(8)
  v_pk_add_f32 v[16:17], v[16:17], v[104:105]
  v_pk_add_f32 v[18:19], v[18:19], v[106:107]
  v_pk_add_f32 v[20:21], v[20:21], v[108:109]
  v_pk_add_f32 v[22:23], v[22:23], v[110:111]
  s_waitcnt vmcnt(6)
  v_pk_add_f32 v[16:17], v[16:17], v[112:113]
  v_pk_add_f32 v[18:19], v[18:19], v[114:115]
  v_pk_add_f32 v[20:21], v[20:21], v[116:117]
  v_pk_add_f32 v[22:23], v[22:23], v[118:119]
  s_waitcnt vmcnt(4)
  v_pk_add_f32 v[16:17], v[16:17], v[120:121]
  v_pk_add_f32 v[18:19], v[18:19], v[122:123]
  v_pk_add_f32 v[20:21], v[20:21], v[124:125]
  v_pk_add_f32 v[22:23], v[22:23], v[126:127]
  s_waitcnt vmcnt(2)
  v_pk_add_f32 v[16:17], v[16:17], v[128:129]
  v_pk_add_f32 v[18:19], v[18:19], v[130:131]
  v_pk_add_f32 v[20:21], v[20:21], v[132:133]
  v_pk_add_f32 v[22:23], v[22:23], v[134:135]
  s_waitcnt vmcnt(0)
  v_pk_add_f32 v[16:17], v[16:17], v[136:137]
  v_pk_add_f32 v[18:19], v[18:19], v[138:139]
  v_pk_add_f32 v[20:21], v[20:21], v[140:141]
  v_pk_add_f32 v[22:23], v[22:23], v[142:143]
  v_cvt_pk_bf16_f32 v12, v16, v17
  v_cvt_pk_bf16_f32 v13, v18, v19
  v_cvt_pk_bf16_f32 v14, v20, v21
  v_cvt_pk_bf16_f32 v15, v22, v23
  buffer_store_dwordx4 v[12:15], v10, s[8:11], s12 offen sc1
  s_barrier
  s_mov_b64 exec, -1
  s_setprio 2
L_s2_nored:
  s_add_u32 m0, s54, 0
  s_add_u32 s64, s60, 0
  buffer_load_dwordx4 v4, s[8:11], s64 offen lds
  s_add_u32 m0, s54, 5120
  s_add_u32 s64, s60, 20480
  buffer_load_dwordx4 v4, s[8:11], s64 offen lds
  s_add_u32 m0, s54, 10240
  s_add_u32 s64, s60, 40960
  buffer_load_dwordx4 v4, s[8:11], s64 offen lds
  s_add_u32 m0, s54, 15360
  s_add_u32 s64, s60, 61440
  buffer_load_dwordx4 v4, s[8:11], s64 offen lds
  s_add_u32 m0, s54, 1024
  s_add_u32 s64, s60, 1024
  buffer_load_dwordx4 v4, s[8:11], s64 offen lds
  s_add_u32 m0, s54, 6144
  s_add_u32 s64, s60, 21504
  buffer_load_dwordx4 v4, s[8:11], s64 offen lds
  s_add_u32 m0, s54, 11264
  s_add_u32 s64, s60, 41984
  buffer_load_dwordx4 v4, s[8:11], s64 offen lds
  s_add_u32 m0, s54, 16384
  s_add_u32 s64, s60, 62464
  buffer_load_dwordx4 v4, s[8:11], s64 offen lds
  s_add_u32 m0, s54, 2048
  s_add_u32 s64, s60, 2048
  buffer_load_dwordx4 v4, s[8:11], s64 offen lds
  s_add_u32 m0, s54, 7168
  s_add_u32 s64, s60, 22528
  buffer_load_dwordx4 v4, s[8:11], s64 offen lds
  s_add_u32 m0, s54, 12288
  s_add_u32 s64, s60, 43008
  buffer_load_dwordx4 v4, s[8:11], s64 offen lds
  s_add_u32 m0, s54, 17408
  s_add_u32 s64, s60, 63488
  buffer_load_dwordx4 v4, s[8:11], s64 offen lds
  s_add_u32 m0, s54, 3072
  s_add_u32 s64, s60, 3072
  buffer_load_dwordx4 v4, s[8:11], s64 offen lds
  s_add_u32 m0, s54, 8192
  s_add_u32 s64, s60, 23552
  buffer_load_dwordx4 v4, s[8:11], s64 offen lds
  s_add_u32 m0, s54, 13312
  s_add_u32 s64, s60, 44032
  buffer_load_dwordx4 v4, s[8:11], s64 offen lds
  s_add_u32 m0, s54, 18432
  s_add_u32 s64, s60, 64512
  buffer_load_dwordx4 v4, s[8:11], s64 offen lds
  s_add_u32 m0, s54, 4096
  s_add_u32 s64, s60, 4096
  buffer_load_dwordx4 v4, s[8:11], s64 offen lds
  s_add_u32 m0, s54, 9216
  s_add_u32 s64, s60, 24576
  buffer_load_dwordx4 v4, s[8:11], s64 offen lds
  s_add_u32 m0, s54, 14336
  s_add_u32 s64, s60, 45056
  buffer_load_dwordx4 v4, s[8:11], s64 offen lds
  s_add_u32 m0, s54, 19456
  s_add_u32 s64, s60, 65536
  buffer_load_dwordx4 v4, s[8:11], s64 offen lds
  v_cmp_gt_u32 s[82:83], 48, v1
  v_cmp_gt_u32 s[84:85], 32, v1
  s_lshl_b32 s61, s58, 3
  s_mul_i32 s61, s61, 1536
  s_add_u32 s61, s61, 0xa00000
  v_lshrrev_b32 v0, 2, v2
  v_cmp_ne_u32 s[66:67], 0, v0
  v_cmp_eq_u32 s[74:75], 0, v3
  v_cmp_ne_u32 s[68:69], 1, v0
  v_cmp_eq_u32 s[76:77], 1, v3
  v_cmp_ne_u32 s[70:71], 2, v0
  v_cmp_eq_u32 s[78:79], 2, v3
  v_cmp_ne_u32 s[72:73], 3, v0
  v_cmp_eq_u32 s[80:81], 3, v3
  v_cmp_eq_u32 vcc, 4, v2
  s_orn2_b64 s[40:41], vcc, s[66:67]
  v_cmp_eq_u32 vcc, 8, v2
  s_orn2_b64 s[42:43], vcc, s[68:69]
  v_cmp_eq_u32 vcc, 12, v2
  s_orn2_b64 s[44:45], vcc, s[70:71]
  v_cmp_eq_u32 vcc, 0, v2
  s_orn2_b64 s[46:47], vcc, s[72:73]
  v_pk_mov_b32 v[144:145], 0, 0
  v_pk_mov_b32 v[146:147], 0, 0
  v_pk_mov_b32 v[148:149], 0, 0
  v_pk_mov_b32 v[150:151], 0, 0
  v_pk_mov_b32 v[152:153], 0, 0
  v_pk_mov_b32 v[154:155], 0, 0
  v_pk_mov_b32 v[156:157], 0, 0
  v_pk_mov_b32 v[158:159], 0, 0
  v_pk_mov_b32 v[160:161], 0, 0
  v_pk_mov_b32 v[162:163], 0, 0
  v_pk_mov_b32 v[164:165], 0, 0
  v_pk_mov_b32 v[166:167], 0, 0
  v_pk_mov_b32 v[168:169], 0, 0
  v_pk_mov_b32 v[170:171], 0, 0
  v_pk_mov_b32 v[172:173], 0, 0
  v_pk_mov_b32 v[174:175], 0, 0
  v_pk_mov_b32 v[176:177], 0, 0
  v_pk_mov_b32 v[178:179], 0, 0
  v_pk_mov_b32 v[180:181], 0, 0
  v_pk_mov_b32 v[182:183], 0, 0
  v_pk_mov_b32 v[184:185], 0, 0
  v_pk_mov_b32 v[186:187], 0, 0
  v_pk_mov_b32 v[188:189], 0, 0
  v_pk_mov_b32 v[190:191], 0, 0
  v_pk_mov_b32 v[192:193], 0, 0
  v_pk_mov_b32 v[194:195], 0, 0
  v_pk_mov_b32 v[196:197], 0, 0
  v_pk_mov_b32 v[198:199], 0, 0
  v_pk_mov_b32 v[200:201], 0, 0
  v_pk_mov_b32 v[202:203], 0, 0
  v_pk_mov_b32 v[204:205], 0, 0
  v_pk_mov_b32 v[206:207], 0, 0
  s_mov_b32 s19, 0
L_s2_fsetup:
  v_pk_mov_b32 v[8:9], 0, 0
  v_pk_mov_b32 v[10:11], 0, 0
  v_pk_mov_b32 v[12:13], 0, 0
  v_pk_mov_b32 v[14:15], 0, 0
  v_pk_mov_b32 v[16:17], 0, 0
  v_pk_mov_b32 v[18:19], 0, 0
  v_pk_mov_b32 v[20:21], 0, 0
  v_pk_mov_b32 v[22:23], 0, 0
  v_pk_mov_b32 v[24:25], 0, 0
  v_pk_mov_b32 v[26:27], 0, 0
  v_pk_mov_b32 v[28:29], 0, 0
  v_pk_mov_b32 v[30:31], 0, 0
  v_pk_mov_b32 v[32:33], 0, 0
  v_pk_mov_b32 v[34:35], 0, 0
  v_pk_mov_b32 v[36:37], 0, 0
  v_pk_mov_b32 v[38:39], 0, 0
  s_mov_b32 s63, 0
L_s2_fpoll:
  s_mov_b64 exec, s[82:83]
  s_add_u32 s62, s61, 0
  buffer_load_dwordx4 v[8:11], v4, s[8:11], s62 offen sc1
  buffer_load_dwordx4 v[12:15], v4, s[8:11], s62 offen offset:768 sc1
  s_add_u32 s62, s61, 1536
  buffer_load_dwordx4 v[16:19], v4, s[8:11], s62 offen sc1
  buffer_load_dwordx4 v[20:23], v4, s[8:11], s62 offen offset:768 sc1
  s_add_u32 s62, s61, 3072
  buffer_load_dwordx4 v[24:27], v4, s[8:11], s62 offen sc1
  buffer_load_dwordx4 v[28:31], v4, s[8:11], s62 offen offset:768 sc1
  s_add_u32 s62, s61, 4608
  buffer_load_dwordx4 v[32:35], v4, s[8:11], s62 offen sc1
  buffer_load_dwordx4 v[36:39], v4, s[8:11], s62 offen offset:768 sc1
  s_add_u32 s62, s61, 6144
  buffer_load_dwordx4 v[176:179], v4, s[8:11], s62 offen sc1
  buffer_load_dwordx4 v[180:183], v4, s[8:11], s62 offen offset:768 sc1
  s_add_u32 s62, s61, 7680
  buffer_load_dwordx4 v[184:187], v4, s[8:11], s62 offen sc1
  buffer_load_dwordx4 v[188:191], v4, s[8:11], s62 offen offset:768 sc1
  s_add_u32 s62, s61, 9216
  buffer_load_dwordx4 v[192:195], v4, s[8:11], s62 offen sc1
  buffer_load_dwordx4 v[196:199], v4, s[8:11], s62 offen offset:768 sc1
  s_add_u32 s62, s61, 10752
  buffer_load_dwordx4 v[200:203], v4, s[8:11], s62 offen sc1
  buffer_load_dwordx4 v[204:207], v4, s[8:11], s62 offen offset:768 sc1
  s_waitcnt vmcnt(0)
  s_mov_b64 s[64:65], 0
  v_cmp_eq_u32 vcc, -1, v8
  s_or_b64 s[64:65], s[64:65], vcc
  v_cmp_eq_u32 vcc, -1, v12
  s_and_b64 vcc, vcc, s[40:41]
  s_or_b64 s[64:65], s[64:65], vcc
  v_cmp_eq_u32 vcc, -1, v16
  s_or_b64 s[64:65], s[64:65], vcc
  v_cmp_eq_u32 vcc, -1, v20
  s_and_b64 vcc, vcc, s[42:43]
  s_or_b64 s[64:65], s[64:65], vcc
  v_cmp_eq_u32 vcc, -1, v24
  s_or_b64 s[64:65], s[64:65], vcc
  v_cmp_eq_u32 vcc, -1, v28
  s_and_b64 vcc, vcc, s[44:45]
  s_or_b64 s[64:65], s[64:65], vcc
  v_cmp_eq_u32 vcc, -1, v32
  s_or_b64 s[64:65], s[64:65], vcc
  v_cmp_eq_u32 vcc, -1, v36
  s_and_b64 vcc, vcc, s[46:47]
  s_or_b64 s[64:65], s[64:65], vcc
  v_cmp_eq_u32 vcc, -1, v176
  s_or_b64 s[64:65], s[64:65], vcc
  v_cmp_eq_u32 vcc, -1, v180
  s_and_b64 vcc, vcc, s[40:41]
  s_or_b64 s[64:65], s[64:65], vcc
  v_cmp_eq_u32 vcc, -1, v184
  s_or_b64 s[64:65], s[64:65], vcc
  v_cmp_eq_u32 vcc, -1, v188
  s_and_b64 vcc, vcc, s[42:43]
  s_or_b64 s[64:65], s[64:65], vcc
  v_cmp_eq_u32 vcc, -1, v192
  s_or_b64 s[64:65], s[64:65], vcc
  v_cmp_eq_u32 vcc, -1, v196
  s_and_b64 vcc, vcc, s[44:45]
  s_or_b64 s[64:65], s[64:65], vcc
  v_cmp_eq_u32 vcc, -1, v200
  s_or_b64 s[64:65], s[64:65], vcc
  v_cmp_eq_u32 vcc, -1, v204
  s_and_b64 vcc, vcc, s[46:47]
  s_or_b64 s[64:65], s[64:65], vcc
  s_mov_b64 exec, -1
  s_add_u32 s63, s63, 1
  s_cmp_eq_u64 s[64:65], 0
  s_cbranch_scc1 L_s2_fok
  s_cmp_ge_u32 s63, 4000
  s_cbranch_scc1 L_s2_ffall
  s_sleep 6
  s_branch L_s2_fpoll
L_s2_ffall:
  s_cmp_lg_u32 s19, 0
  s_cbranch_scc1 L_s2_fok
  s_mov_b32 s19, 1
  s_lshl_b32 s18, s58, 3
  s_add_u32 s15, s18, 8
L_s2_floop:
  v_mul_u32_u24 v8, 171, v1
  v_lshrrev_b32 v8, 9, v8
  v_mul_u32_u24 v9, 3, v8
  v_sub_u32 v9, v1, v9
  v_mul_u32_u24 v6, 80, v8
  v_lshl_add_u32 v6, v9, 5, v6
  v_add_u32 v7, 16, v6
  v_mov_b32 v10, 0x7000000
  v_cmp_eq_u32 vcc, 2, v9
  s_mul_i32 s12, s18, 1680
  s_add_u32 s12, s12, 0x900000
  s_nop 0
  v_cndmask_b32 v7, v7, v10, vcc
  v_cmp_gt_u32 vcc, 63, v1
  s_and_saveexec_b64 s[16:17], vcc
  buffer_load_dwordx4 v[16:19], v6, s[8:11], s12 offen
  buffer_load_dwordx4 v[20:23], v7, s[8:11], s12 offen
  s_add_u32 s12, s12, 53760
  buffer_load_dwordx4 v[24:27], v6, s[8:11], s12 offen
  buffer_load_dwordx4 v[28:31], v7, s[8:11], s12 offen
  s_add_u32 s12, s12, 53760
  buffer_load_dwordx4 v[32:35], v6, s[8:11], s12 offen
  buffer_load_dwordx4 v[36:39], v7, s[8:11], s12 offen
  s_add_u32 s12, s12, 53760
  buffer_load_dwordx4 v[40:43], v6, s[8:11], s12 offen
  buffer_load_dwordx4 v[44:47], v7, s[8:11], s12 offen
  s_add_u32 s12, s12, 53760
  buffer_load_dwordx4 v[48:51], v6, s[8:11], s12 offen
  buffer_load_dwordx4 v[52:55], v7, s[8:11], s12 offen
  s_add_u32 s12, s12, 53760
  buffer_load_dwordx4 v[56:59], v6, s[8:11], s12 offen
  buffer_load_dwordx4 v[60:63], v7, s[8:11], s12 offen
  s_add_u32 s12, s12, 53760
  buffer_load_dwordx4 v[64:67], v6, s[8:11], s12 offen
  buffer_load_dwordx4 v[68:71], v7, s[8:11], s12 offen
  s_add_u32 s12, s12, 53760
  buffer_load_dwordx4 v[72:75], v6, s[8:11], s12 offen
  buffer_load_dwordx4 v[76:79], v7, s[8:11], s12 offen
  s_add_u32 s12, s12, 53760
  buffer_load_dwordx4 v[80:83], v6, s[8:11], s12 offen
  buffer_load_dwordx4 v[84:87], v7, s[8:11], s12 offen
  s_add_u32 s12, s12, 53760
  buffer_load_dwordx4 v[88:91], v6, s[8:11], s12 offen
  buffer_load_dwordx4 v[92:95], v7, s[8:11], s12 offen
  s_add_u32 s12, s12, 53760
  buffer_load_dwordx4 v[96:99], v6, s[8:11], s12 offen
  buffer_load_dwordx4 v[100:103], v7, s[8:11], s12 offen
  s_add_u32 s12, s12, 53760
  buffer_load_dwordx4 v[104:107], v6, s[8:11], s12 offen
  buffer_load_dwordx4 v[108:111], v7, s[8:11], s12 offen
  s_add_u32 s12, s12, 53760
  buffer_load_dwordx4 v[112:115], v6, s[8:11], s12 offen
  buffer_load_dwordx4 v[116:119], v7, s[8:11], s12 offen
  s_add_u32 s12, s12, 53760
  buffer_load_dwordx4 v[120:123], v6, s[8:11], s12 offen
  buffer_load_dwordx4 v[124:127], v7, s[8:11], s12 offen
  s_add_u32 s12, s12, 53760
  buffer_load_dwordx4 v[128:131], v6, s[8:11], s12 offen
  buffer_load_dwordx4 v[132:135], v7, s[8:11], s12 offen
  s_add_u32 s12, s12, 53760
  buffer_load_dwordx4 v[136:139], v6, s[8:11], s12 offen
  buffer_load_dwordx4 v[140:143], v7, s[8:11], s12 offen
  s_and_b32 s13, s18, 3
  s_lshl_b32 s13, s13, 2
  s_sub_u32 s14, s13, 16
  v_add_u32 v10, s14, v8
  v_and_b32 v10, 15, v10
  v_add_u32 v10, 48, v10
  v_cmp_gt_u32 vcc, 16, v8
  s_mul_i32 s12, s18, 1536
  s_add_u32 s12, s12, 0xa00000
  v_cndmask_b32 v10, v10, v8, vcc
  v_lshlrev_b32 v10, 4, v10
  v_lshl_add_u32 v10, v9, 8, v10
  s_waitcnt vmcnt(28)
  v_pk_add_f32 v[16:17], v[16:17], v[24:25]
  v_pk_add_f32 v[18:19], v[18:19], v[26:27]
  v_pk_add_f32 v[20:21], v[20:21], v[28:29]
  v_pk_add_f32 v[22:23], v[22:23], v[30:31]
  s_waitcnt vmcnt(26)
  v_pk_add_f32 v[16:17], v[16:17], v[32:33]
  v_pk_add_f32 v[18:19], v[18:19], v[34:35]
  v_pk_add_f32 v[20:21], v[20:21], v[36:37]
  v_pk_add_f32 v[22:23], v[22:23], v[38:39]
  s_waitcnt vmcnt(24)
  v_pk_add_f32 v[16:17], v[16:17], v[40:41]
  v_pk_add_f32 v[18:19], v[18:19], v[42:43]
  v_pk_add_f32 v[20:21], v[20:21], v[44:45]
  v_pk_add_f32 v[22:23], v[22:23], v[46:47]
  s_waitcnt vmcnt(22)
  v_pk_add_f32 v[16:17], v[16:17], v[48:49]
  v_pk_add_f32 v[18:19], v[18:19], v[50:51]
  v_pk_add_f32 v[20:21], v[20:21], v[52:53]
  v_pk_add_f32 v[22:23], v[22:23], v[54:55]
  s_waitcnt vmcnt(20)
  v_pk_add_f32 v[16:17], v[16:17], v[56:57]
  v_pk_add_f32 v[18:19], v[18:19], v[58:59]
  v_pk_add_f32 v[20:21], v[20:21], v[60:61]
  v_pk_add_f32 v[22:23], v[22:23], v[62:63]
  s_waitcnt vmcnt(18)
  v_pk_add_f32 v[16:17], v[16:17], v[64:65]
  v_pk_add_f32 v[18:19], v[18:19], v[66:67]
  v_pk_add_f32 v[20:21], v[20:21], v[68:69]
  v_pk_add_f32 v[22:23], v[22:23], v[70:71]
  s_waitcnt vmcnt(16)
  v_pk_add_f32 v[16:17], v[16:17], v[72:73]
  v_pk_add_f32 v[18:19], v[18:19], v[74:75]
  v_pk_add_f32 v[20:21], v[20:21], v[76:77]
  v_pk_add_f32 v[22:23], v[22:23], v[78:79]
  s_waitcnt vmcnt(14)
  v_pk_add_f32 v[16:17], v[16:17], v[80:81]
  v_pk_add_f32 v[18:19], v[18:19], v[82:83]
  v_pk_add_f32 v[20:21], v[20:21], v[84:85]
  v_pk_add_f32 v[22:23], v[22:23], v[86:87]
  s_waitcnt vmcnt(12)
  v_pk_add_f32 v[16:17], v[16:17], v[88:89]
  v_pk_add_f32 v[18:19], v[18:19], v[90:91]
  v_pk_add_f32 v[20:21], v[20:21], v[92:93]
  v_pk_add_f32 v[22:23], v[22:23], v[94:95]
  s_waitcnt vmcnt(10)
  v_pk_add_f32 v[16:17], v[16:17], v[96:97]
  v_pk_add_f32 v[18:19], v[18:19], v[98:99]
  v_pk_add_f32 v[20:21], v[20:21], v[100:101]
  v_pk_add_f32 v[22:23], v[22:23], v[102:103]
  s_waitcnt vmcnt(8)
  v_pk_add_f32 v[16:17], v[16:17], v[104:105]
  v_pk_add_f32 v[18:19], v[18:19], v[106:107]
  v_pk_add_f32 v[20:21], v[20:21], v[108:109]
  v_pk_add_f32 v[22:23], v[22:23], v[110:111]
  s_waitcnt vmcnt(6)
  v_pk_add_f32 v[16:17], v[16:17], v[112:113]
  v_pk_add_f32 v[18:19], v[18:19], v[114:115]
  v_pk_add_f32 v[20:21], v[20:21], v[116:117]
  v_pk_add_f32 v[22:23], v[22:23], v[118:119]
  s_waitcnt vmcnt(4)
  v_pk_add_f32 v[16:17], v[16:17], v[120:121]
  v_pk_add_f32 v[18:19], v[18:19], v[122:123]
  v_pk_add_f32 v[20:21], v[20:21], v[124:125]
  v_pk_add_f32 v[22:23], v[22:23], v[126:127]
  s_waitcnt vmcnt(2)
  v_pk_add_f32 v[16:17], v[16:17], v[128:129]
  v_pk_add_f32 v[18:19], v[18:19], v[130:131]
  v_pk_add_f32 v[20:21], v[20:21], v[132:133]
  v_pk_add_f32 v[22:23], v[22:23], v[134:135]
  s_waitcnt vmcnt(0)
  v_pk_add_f32 v[16:17], v[16:17], v[136:137]
  v_pk_add_f32 v[18:19], v[18:19], v[138:139]
  v_pk_add_f32 v[20:21], v[20:21], v[140:141]
  v_pk_add_f32 v[22:23], v[22:23], v[142:143]
  v_cvt_pk_bf16_f32 v12, v16, v17
  v_cvt_pk_bf16_f32 v13, v18, v19
  v_cvt_pk_bf16_f32 v14, v20, v21
  v_cvt_pk_bf16_f32 v15, v22, v23
  buffer_store_dwordx4 v[12:15], v10, s[8:11], s12 offen sc1
  s_mov_b64 exec, -1
  s_nop 1
  s_add_u32 s18, s18, 1
  s_cmp_lt_u32 s18, s15
  s_cbranch_scc1 L_s2_floop
  s_waitcnt vmcnt(0)
  s_branch L_s2_fsetup
L_s2_fok:
  buffer_load_dword v76, v5, s[8:11], 0 offen offset:0
  buffer_load_dword v77, v5, s[8:11], 0 offen offset:64
  buffer_load_dword v78, v5, s[8:11], 0 offen offset:128
  buffer_load_dword v79, v5, s[8:11], 0 offen offset:192
  v_lshlrev_b32 v6, 8, v3
  v_lshl_add_u32 v6, v2, 3, v6
  v_add_u32 v6, s54, v6
  v_add_u32 v7, s54, v4
  v_pk_mov_b32 v[40:41], 0, 0
  v_pk_mov_b32 v[42:43], 0, 0
  v_pk_mov_b32 v[44:45], 0, 0
  v_pk_mov_b32 v[46:47], 0, 0
  v_pk_mov_b32 v[48:49], 0, 0
  v_pk_mov_b32 v[50:51], 0, 0
  v_pk_mov_b32 v[52:53], 0, 0
  v_pk_mov_b32 v[54:55], 0, 0
  v_pk_mov_b32 v[56:57], 0, 0
  v_pk_mov_b32 v[58:59], 0, 0
  v_pk_mov_b32 v[60:61], 0, 0
  v_pk_mov_b32 v[62:63], 0, 0
  v_pk_mov_b32 v[64:65], 0, 0
  v_pk_mov_b32 v[66:67], 0, 0
  v_pk_mov_b32 v[68:69], 0, 0
  v_pk_mov_b32 v[70:71], 0, 0
  v_pk_mov_b32 v[80:81], 0, 0
  v_pk_mov_b32 v[82:83], 0, 0
  v_pk_mov_b32 v[84:85], 0, 0
  v_pk_mov_b32 v[86:87], 0, 0
  v_mov_b32 v88, 0x358637bd
  v_mov_b32 v89, 0x358637bd
  v_mov_b32 v90, 0x358637bd
  v_mov_b32 v91, 0x358637bd
  s_mov_b64 exec, s[82:83]
  ds_read_b64 v[40:41], v6 offset:0
  ds_read_b64 v[44:45], v6 offset:5120
  ds_read_b64 v[48:49], v6 offset:10240
  ds_read_b64 v[52:53], v6 offset:15360
  s_mov_b64 exec, s[84:85]
  ds_read_b64 v[42:43], v6 offset:128
  ds_read_b64 v[46:47], v6 offset:5248
  ds_read_b64 v[50:51], v6 offset:10368
  ds_read_b64 v[54:55], v6 offset:15488
  s_mov_b64 exec, -1
  v_mov_b32_dpp v72, v12 row_newbcast:4 row_mask:0xf bank_mask:0xf
  v_mov_b32_dpp v73, v13 row_newbcast:4 row_mask:0xf bank_mask:0xf
  v_mov_b32_dpp v74, v14 row_newbcast:4 row_mask:0xf bank_mask:0xf
  v_mov_b32_dpp v75, v15 row_newbcast:4 row_mask:0xf bank_mask:0xf
  s_nop 0
  v_cndmask_b32 v12, v12, 0, s[66:67]
  v_cndmask_b32 v13, v13, 0, s[66:67]
  v_cndmask_b32 v14, v14, 0, s[66:67]
  v_cndmask_b32 v15, v15, 0, s[66:67]
  s_waitcnt lgkmcnt(0)
  s_mov_b64 exec, s[82:83]
  ds_read_b64 v[56:57], v6 offset:640
  ds_read_b64 v[60:61], v6 offset:5760
  ds_read_b64 v[64:65], v6 offset:10880
  ds_read_b64 v[68:69], v6 offset:16000
  s_mov_b64 exec, s[84:85]
  ds_read_b64 v[58:59], v6 offset:768
  ds_read_b64 v[62:63], v6 offset:5888
  ds_read_b64 v[66:67], v6 offset:11008
  ds_read_b64 v[70:71], v6 offset:16128
  s_mov_b64 exec, -1
  v_mfma_f32_16x16x32_bf16 v[116:119], v[72:75], v[40:43], v[88:91]
  v_mfma_f32_16x16x32_bf16 v[124:127], v[72:75], v[44:47], v[88:91]
  v_mfma_f32_16x16x32_bf16 v[132:135], v[72:75], v[48:51], v[88:91]
  v_mfma_f32_16x16x32_bf16 v[140:143], v[72:75], v[52:55], v[88:91]
  v_mfma_f32_16x16x32_bf16 v[112:115], v[8:11], v[40:43], 0
  v_mfma_f32_16x16x32_bf16 v[120:123], v[8:11], v[44:47], 0
  v_mfma_f32_16x16x32_bf16 v[128:131], v[8:11], v[48:51], 0
  v_mfma_f32_16x16x32_bf16 v[136:139], v[8:11], v[52:55], 0
  v_mfma_f32_16x16x32_bf16 v[144:147], v[12:15], v[40:43], v[144:147]
  v_mfma_f32_16x16x32_bf16 v[148:151], v[12:15], v[44:47], v[148:151]
  v_mfma_f32_16x16x32_bf16 v[152:155], v[12:15], v[48:51], v[152:155]
  v_mfma_f32_16x16x32_bf16 v[156:159], v[12:15], v[52:55], v[156:159]
  v_rcp_f32 v116, v116
  v_rcp_f32 v124, v124
  v_rcp_f32 v132, v132
  v_rcp_f32 v140, v140
  s_waitcnt vmcnt(0)
  v_mul_f32 v116, v116, v76
  v_mul_f32 v124, v124, v77
  v_mul_f32 v132, v132, v78
  v_mul_f32 v140, v140, v79
  v_pk_mul_f32 v[112:113], v[112:113], v[116:117] op_sel_hi:[1,0]
  v_pk_mul_f32 v[114:115], v[114:115], v[116:117] op_sel_hi:[1,0]
  v_pk_mul_f32 v[120:121], v[120:121], v[124:125] op_sel_hi:[1,0]
  v_pk_mul_f32 v[122:123], v[122:123], v[124:125] op_sel_hi:[1,0]
  v_pk_mul_f32 v[128:129], v[128:129], v[132:133] op_sel_hi:[1,0]
  v_pk_mul_f32 v[130:131], v[130:131], v[132:133] op_sel_hi:[1,0]
  v_pk_mul_f32 v[136:137], v[136:137], v[140:141] op_sel_hi:[1,0]
  v_pk_mul_f32 v[138:139], v[138:139], v[140:141] op_sel_hi:[1,0]
  v_cndmask_b32 v80, v80, v116, s[74:75]
  v_cndmask_b32 v81, v81, v124, s[74:75]
  v_cndmask_b32 v82, v82, v132, s[74:75]
  v_cndmask_b32 v83, v83, v140, s[74:75]
  v_cvt_pk_bf16_f32 v96, v112, v113
  v_cvt_pk_bf16_f32 v97, v114, v115
  v_cvt_pk_bf16_f32 v100, v120, v121
  v_cvt_pk_bf16_f32 v101, v122, v123
  v_cvt_pk_bf16_f32 v104, v128, v129
  v_cvt_pk_bf16_f32 v105, v130, v131
  v_cvt_pk_bf16_f32 v108, v136, v137
  v_cvt_pk_bf16_f32 v109, v138, v139
  v_mov_b32_dpp v72, v20 row_newbcast:8 row_mask:0xf bank_mask:0xf
  v_mov_b32_dpp v73, v21 row_newbcast:8 row_mask:0xf bank_mask:0xf
  v_mov_b32_dpp v74, v22 row_newbcast:8 row_mask:0xf bank_mask:0xf
  v_mov_b32_dpp v75, v23 row_newbcast:8 row_mask:0xf bank_mask:0xf
  s_nop 0
  v_cndmask_b32 v20, v20, 0, s[68:69]
  v_cndmask_b32 v21, v21, 0, s[68:69]
  v_cndmask_b32 v22, v22, 0, s[68:69]
  v_cndmask_b32 v23, v23, 0, s[68:69]
  s_waitcnt lgkmcnt(0)
  s_mov_b64 exec, s[82:83]
  ds_read_b64 v[40:41], v6 offset:1280
  ds_read_b64 v[44:45], v6 offset:6400
  ds_read_b64 v[48:49], v6 offset:11520
  ds_read_b64 v[52:53], v6 offset:16640
  s_mov_b64 exec, s[84:85]
  ds_read_b64 v[42:43], v6 offset:1408
  ds_read_b64 v[46:47], v6 offset:6528
  ds_read_b64 v[50:51], v6 offset:11648
  ds_read_b64 v[54:55], v6 offset:16768
  s_mov_b64 exec, -1
  v_mfma_f32_16x16x32_bf16 v[116:119], v[72:75], v[56:59], v[88:91]
  v_mfma_f32_16x16x32_bf16 v[124:127], v[72:75], v[60:63], v[88:91]
  v_mfma_f32_16x16x32_bf16 v[132:135], v[72:75], v[64:67], v[88:91]
  v_mfma_f32_16x16x32_bf16 v[140:143], v[72:75], v[68:71], v[88:91]
  v_mfma_f32_16x16x32_bf16 v[112:115], v[16:19], v[56:59], 0
  v_mfma_f32_16x16x32_bf16 v[120:123], v[16:19], v[60:63], 0
  v_mfma_f32_16x16x32_bf16 v[128:131], v[16:19], v[64:67], 0
  v_mfma_f32_16x16x32_bf16 v[136:139], v[16:19], v[68:71], 0
  v_mfma_f32_16x16x32_bf16 v[144:147], v[20:23], v[56:59], v[144:147]
  v_mfma_f32_16x16x32_bf16 v[148:151], v[20:23], v[60:63], v[148:151]
  v_mfma_f32_16x16x32_bf16 v[152:155], v[20:23], v[64:67], v[152:155]
  v_mfma_f32_16x16x32_bf16 v[156:159], v[20:23], v[68:71], v[156:159]
  v_rcp_f32 v116, v116
  v_rcp_f32 v124, v124
  v_rcp_f32 v132, v132
  v_rcp_f32 v140, v140
  s_nop 0
  v_mul_f32 v116, v116, v76
  v_mul_f32 v124, v124, v77
  v_mul_f32 v132, v132, v78
  v_mul_f32 v140, v140, v79
  v_pk_mul_f32 v[112:113], v[112:113], v[116:117] op_sel_hi:[1,0]
  v_pk_mul_f32 v[114:115], v[114:115], v[116:117] op_sel_hi:[1,0]
  v_pk_mul_f32 v[120:121], v[120:121], v[124:125] op_sel_hi:[1,0]
  v_pk_mul_f32 v[122:123], v[122:123], v[124:125] op_sel_hi:[1,0]
  v_pk_mul_f32 v[128:129], v[128:129], v[132:133] op_sel_hi:[1,0]
  v_pk_mul_f32 v[130:131], v[130:131], v[132:133] op_sel_hi:[1,0]
  v_pk_mul_f32 v[136:137], v[136:137], v[140:141] op_sel_hi:[1,0]
  v_pk_mul_f32 v[138:139], v[138:139], v[140:141] op_sel_hi:[1,0]
  v_cndmask_b32 v80, v80, v116, s[76:77]
  v_cndmask_b32 v81, v81, v124, s[76:77]
  v_cndmask_b32 v82, v82, v132, s[76:77]
  v_cndmask_b32 v83, v83, v140, s[76:77]
  v_cvt_pk_bf16_f32 v98, v112, v113
  v_cvt_pk_bf16_f32 v99, v114, v115
  v_cvt_pk_bf16_f32 v102, v120, v121
  v_cvt_pk_bf16_f32 v103, v122, v123
  v_cvt_pk_bf16_f32 v106, v128, v129
  v_cvt_pk_bf16_f32 v107, v130, v131
  v_cvt_pk_bf16_f32 v110, v136, v137
  v_cvt_pk_bf16_f32 v111, v138, v139
  s_waitcnt lgkmcnt(0)
  ds_write_b128 v7, v[96:99] offset:0
  ds_write_b128 v7, v[100:103] offset:5120
  ds_write_b128 v7, v[104:107] offset:10240
  ds_write_b128 v7, v[108:111] offset:15360
  v_mov_b32_dpp v72, v28 row_newbcast:12 row_mask:0xf bank_mask:0xf
  v_mov_b32_dpp v73, v29 row_newbcast:12 row_mask:0xf bank_mask:0xf
  v_mov_b32_dpp v74, v30 row_newbcast:12 row_mask:0xf bank_mask:0xf
  v_mov_b32_dpp v75, v31 row_newbcast:12 row_mask:0xf bank_mask:0xf
  s_nop 0
  v_cndmask_b32 v28, v28, 0, s[70:71]
  v_cndmask_b32 v29, v29, 0, s[70:71]
  v_cndmask_b32 v30, v30, 0, s[70:71]
  v_cndmask_b32 v31, v31, 0, s[70:71]
  s_waitcnt lgkmcnt(0)
  s_mov_b64 exec, s[82:83]
  ds_read_b64 v[56:57], v6 offset:1920
  ds_read_b64 v[60:61], v6 offset:7040
  ds_read_b64 v[64:65], v6 offset:12160
  ds_read_b64 v[68:69], v6 offset:17280
  s_mov_b64 exec, s[84:85]
  ds_read_b64 v[58:59], v6 offset:2048
  ds_read_b64 v[62:63], v6 offset:7168
  ds_read_b64 v[66:67], v6 offset:12288
  ds_read_b64 v[70:71], v6 offset:17408
  s_mov_b64 exec, -1
  v_mfma_f32_16x16x32_bf16 v[116:119], v[72:75], v[40:43], v[88:91]
  v_mfma_f32_16x16x32_bf16 v[124:127], v[72:75], v[44:47], v[88:91]
  v_mfma_f32_16x16x32_bf16 v[132:135], v[72:75], v[48:51], v[88:91]
  v_mfma_f32_16x16x32_bf16 v[140:143], v[72:75], v[52:55], v[88:91]
  v_mfma_f32_16x16x32_bf16 v[112:115], v[24:27], v[40:43], 0
  v_mfma_f32_16x16x32_bf16 v[120:123], v[24:27], v[44:47], 0
  v_mfma_f32_16x16x32_bf16 v[128:131], v[24:27], v[48:51], 0
  v_mfma_f32_16x16x32_bf16 v[136:139], v[24:27], v[52:55], 0
  v_mfma_f32_16x16x32_bf16 v[144:147], v[28:31], v[40:43], v[144:147]
  v_mfma_f32_16x16x32_bf16 v[148:151], v[28:31], v[44:47], v[148:151]
  v_mfma_f32_16x16x32_bf16 v[152:155], v[28:31], v[48:51], v[152:155]
  v_mfma_f32_16x16x32_bf16 v[156:159], v[28:31], v[52:55], v[156:159]
  v_rcp_f32 v116, v116
  v_rcp_f32 v124, v124
  v_rcp_f32 v132, v132
  v_rcp_f32 v140, v140
  s_nop 0
  v_mul_f32 v116, v116, v76
  v_mul_f32 v124, v124, v77
  v_mul_f32 v132, v132, v78
  v_mul_f32 v140, v140, v79
  v_pk_mul_f32 v[112:113], v[112:113], v[116:117] op_sel_hi:[1,0]
  v_pk_mul_f32 v[114:115], v[114:115], v[116:117] op_sel_hi:[1,0]
  v_pk_mul_f32 v[120:121], v[120:121], v[124:125] op_sel_hi:[1,0]
  v_pk_mul_f32 v[122:123], v[122:123], v[124:125] op_sel_hi:[1,0]
  v_pk_mul_f32 v[128:129], v[128:129], v[132:133] op_sel_hi:[1,0]
  v_pk_mul_f32 v[130:131], v[130:131], v[132:133] op_sel_hi:[1,0]
  v_pk_mul_f32 v[136:137], v[136:137], v[140:141] op_sel_hi:[1,0]
  v_pk_mul_f32 v[138:139], v[138:139], v[140:141] op_sel_hi:[1,0]
  v_cndmask_b32 v80, v80, v116, s[78:79]
  v_cndmask_b32 v81, v81, v124, s[78:79]
  v_cndmask_b32 v82, v82, v132, s[78:79]
  v_cndmask_b32 v83, v83, v140, s[78:79]
  v_cvt_pk_bf16_f32 v96, v112, v113
  v_cvt_pk_bf16_f32 v97, v114, v115
  v_cvt_pk_bf16_f32 v100, v120, v121
  v_cvt_pk_bf16_f32 v101, v122, v123
  v_cvt_pk_bf16_f32 v104, v128, v129
  v_cvt_pk_bf16_f32 v105, v130, v131
  v_cvt_pk_bf16_f32 v108, v136, v137
  v_cvt_pk_bf16_f32 v109, v138, v139
  v_mov_b32_dpp v72, v36 row_newbcast:0 row_mask:0xf bank_mask:0xf
  v_mov_b32_dpp v73, v37 row_newbcast:0 row_mask:0xf bank_mask:0xf
  v_mov_b32_dpp v74, v38 row_newbcast:0 row_mask:0xf bank_mask:0xf
  v_mov_b32_dpp v75, v39 row_newbcast:0 row_mask:0xf bank_mask:0xf
  s_nop 0
  v_cndmask_b32 v36, v36, 0, s[72:73]
  v_cndmask_b32 v37, v37, 0, s[72:73]
  v_cndmask_b32 v38, v38, 0, s[72:73]
  v_cndmask_b32 v39, v39, 0, s[72:73]
  s_waitcnt lgkmcnt(0)
  s_mov_b64 exec, s[82:83]
  ds_read_b64 v[40:41], v6 offset:2560
  ds_read_b64 v[44:45], v6 offset:7680
  ds_read_b64 v[48:49], v6 offset:12800
  ds_read_b64 v[52:53], v6 offset:17920
  s_mov_b64 exec, s[84:85]
  ds_read_b64 v[42:43], v6 offset:2688
  ds_read_b64 v[46:47], v6 offset:7808
  ds_read_b64 v[50:51], v6 offset:12928
  ds_read_b64 v[54:55], v6 offset:18048
  s_mov_b64 exec, -1
  v_mfma_f32_16x16x32_bf16 v[116:119], v[72:75], v[56:59], v[88:91]
  v_mfma_f32_16x16x32_bf16 v[124:127], v[72:75], v[60:63], v[88:91]
  v_mfma_f32_16x16x32_bf16 v[132:135], v[72:75], v[64:67], v[88:91]
  v_mfma_f32_16x16x32_bf16 v[140:143], v[72:75], v[68:71], v[88:91]
  v_mfma_f32_16x16x32_bf16 v[112:115], v[32:35], v[56:59], 0
  v_mfma_f32_16x16x32_bf16 v[120:123], v[32:35], v[60:63], 0
  v_mfma_f32_16x16x32_bf16 v[128:131], v[32:35], v[64:67], 0
  v_mfma_f32_16x16x32_bf16 v[136:139], v[32:35], v[68:71], 0
  v_mfma_f32_16x16x32_bf16 v[144:147], v[36:39], v[56:59], v[144:147]
  v_mfma_f32_16x16x32_bf16 v[148:151], v[36:39], v[60:63], v[148:151]
  v_mfma_f32_16x16x32_bf16 v[152:155], v[36:39], v[64:67], v[152:155]
  v_mfma_f32_16x16x32_bf16 v[156:159], v[36:39], v[68:71], v[156:159]
  v_rcp_f32 v116, v116
  v_rcp_f32 v124, v124
  v_rcp_f32 v132, v132
  v_rcp_f32 v140, v140
  s_nop 0
  v_mul_f32 v116, v116, v76
  v_mul_f32 v124, v124, v77
  v_mul_f32 v132, v132, v78
  v_mul_f32 v140, v140, v79
  v_pk_mul_f32 v[112:113], v[112:113], v[116:117] op_sel_hi:[1,0]
  v_pk_mul_f32 v[114:115], v[114:115], v[116:117] op_sel_hi:[1,0]
  v_pk_mul_f32 v[120:121], v[120:121], v[124:125] op_sel_hi:[1,0]
  v_pk_mul_f32 v[122:123], v[122:123], v[124:125] op_sel_hi:[1,0]
  v_pk_mul_f32 v[128:129], v[128:129], v[132:133] op_sel_hi:[1,0]
  v_pk_mul_f32 v[130:131], v[130:131], v[132:133] op_sel_hi:[1,0]
  v_pk_mul_f32 v[136:137], v[136:137], v[140:141] op_sel_hi:[1,0]
  v_pk_mul_f32 v[138:139], v[138:139], v[140:141] op_sel_hi:[1,0]
  v_cndmask_b32 v80, v80, v116, s[80:81]
  v_cndmask_b32 v81, v81, v124, s[80:81]
  v_cndmask_b32 v82, v82, v132, s[80:81]
  v_cndmask_b32 v83, v83, v140, s[80:81]
  v_cvt_pk_bf16_f32 v98, v112, v113
  v_cvt_pk_bf16_f32 v99, v114, v115
  v_cvt_pk_bf16_f32 v102, v120, v121
  v_cvt_pk_bf16_f32 v103, v122, v123
  v_cvt_pk_bf16_f32 v106, v128, v129
  v_cvt_pk_bf16_f32 v107, v130, v131
  v_cvt_pk_bf16_f32 v110, v136, v137
  v_cvt_pk_bf16_f32 v111, v138, v139
  s_waitcnt lgkmcnt(0)
  ds_write_b128 v7, v[96:99] offset:1024
  ds_write_b128 v7, v[100:103] offset:6144
  ds_write_b128 v7, v[104:107] offset:11264
  ds_write_b128 v7, v[108:111] offset:16384
  s_waitcnt lgkmcnt(0)
  s_barrier
  v_mov_b32_dpp v72, v180 row_newbcast:4 row_mask:0xf bank_mask:0xf
  v_mov_b32_dpp v73, v181 row_newbcast:4 row_mask:0xf bank_mask:0xf
  v_mov_b32_dpp v74, v182 row_newbcast:4 row_mask:0xf bank_mask:0xf
  v_mov_b32_dpp v75, v183 row_newbcast:4 row_mask:0xf bank_mask:0xf
  s_nop 0
  v_cndmask_b32 v180, v180, 0, s[66:67]
  v_cndmask_b32 v181, v181, 0, s[66:67]
  v_cndmask_b32 v182, v182, 0, s[66:67]
  v_cndmask_b32 v183, v183, 0, s[66:67]
  s_waitcnt lgkmcnt(0)
  s_mov_b64 exec, s[82:83]
  ds_read_b64 v[56:57], v6 offset:3200
  ds_read_b64 v[60:61], v6 offset:8320
  ds_read_b64 v[64:65], v6 offset:13440
  ds_read_b64 v[68:69], v6 offset:18560
  s_mov_b64 exec, s[84:85]
  ds_read_b64 v[58:59], v6 offset:3328
  ds_read_b64 v[62:63], v6 offset:8448
  ds_read_b64 v[66:67], v6 offset:13568
  ds_read_b64 v[70:71], v6 offset:18688
  s_mov_b64 exec, -1
  v_mfma_f32_16x16x32_bf16 v[116:119], v[72:75], v[40:43], v[88:91]
  v_mfma_f32_16x16x32_bf16 v[124:127], v[72:75], v[44:47], v[88:91]
  v_mfma_f32_16x16x32_bf16 v[132:135], v[72:75], v[48:51], v[88:91]
  v_mfma_f32_16x16x32_bf16 v[140:143], v[72:75], v[52:55], v[88:91]
  v_mfma_f32_16x16x32_bf16 v[112:115], v[176:179], v[40:43], 0
  v_mfma_f32_16x16x32_bf16 v[120:123], v[176:179], v[44:47], 0
  v_mfma_f32_16x16x32_bf16 v[128:131], v[176:179], v[48:51], 0
  v_mfma_f32_16x16x32_bf16 v[136:139], v[176:179], v[52:55], 0
  v_mfma_f32_16x16x32_bf16 v[160:163], v[180:183], v[40:43], v[160:163]
  v_mfma_f32_16x16x32_bf16 v[164:167], v[180:183], v[44:47], v[164:167]
  v_mfma_f32_16x16x32_bf16 v[168:171], v[180:183], v[48:51], v[168:171]
  v_mfma_f32_16x16x32_bf16 v[172:175], v[180:183], v[52:55], v[172:175]
  v_rcp_f32 v116, v116
  v_rcp_f32 v124, v124
  v_rcp_f32 v132, v132
  v_rcp_f32 v140, v140
  s_nop 0
  v_mul_f32 v116, v116, v76
  v_mul_f32 v124, v124, v77
  v_mul_f32 v132, v132, v78
  v_mul_f32 v140, v140, v79
  v_pk_mul_f32 v[112:113], v[112:113], v[116:117] op_sel_hi:[1,0]
  v_pk_mul_f32 v[114:115], v[114:115], v[116:117] op_sel_hi:[1,0]
  v_pk_mul_f32 v[120:121], v[120:121], v[124:125] op_sel_hi:[1,0]
  v_pk_mul_f32 v[122:123], v[122:123], v[124:125] op_sel_hi:[1,0]
  v_pk_mul_f32 v[128:129], v[128:129], v[132:133] op_sel_hi:[1,0]
  v_pk_mul_f32 v[130:131], v[130:131], v[132:133] op_sel_hi:[1,0]
  v_pk_mul_f32 v[136:137], v[136:137], v[140:141] op_sel_hi:[1,0]
  v_pk_mul_f32 v[138:139], v[138:139], v[140:141] op_sel_hi:[1,0]
  v_cndmask_b32 v84, v84, v116, s[74:75]
  v_cndmask_b32 v85, v85, v124, s[74:75]
  v_cndmask_b32 v86, v86, v132, s[74:75]
  v_cndmask_b32 v87, v87, v140, s[74:75]
  v_cvt_pk_bf16_f32 v96, v112, v113
  v_cvt_pk_bf16_f32 v97, v114, v115
  v_cvt_pk_bf16_f32 v100, v120, v121
  v_cvt_pk_bf16_f32 v101, v122, v123
  v_cvt_pk_bf16_f32 v104, v128, v129
  v_cvt_pk_bf16_f32 v105, v130, v131
  v_cvt_pk_bf16_f32 v108, v136, v137
  v_cvt_pk_bf16_f32 v109, v138, v139
  v_mov_b32_dpp v72, v188 row_newbcast:8 row_mask:0xf bank_mask:0xf
  v_mov_b32_dpp v73, v189 row_newbcast:8 row_mask:0xf bank_mask:0xf
  v_mov_b32_dpp v74, v190 row_newbcast:8 row_mask:0xf bank_mask:0xf
  v_mov_b32_dpp v75, v191 row_newbcast:8 row_mask:0xf bank_mask:0xf
  s_nop 0
  v_cndmask_b32 v188, v188, 0, s[68:69]
  v_cndmask_b32 v189, v189, 0, s[68:69]
  v_cndmask_b32 v190, v190, 0, s[68:69]
  v_cndmask_b32 v191, v191, 0, s[68:69]
  s_waitcnt lgkmcnt(0)
  s_mov_b64 exec, s[82:83]
  ds_read_b64 v[40:41], v6 offset:3840
  ds_read_b64 v[44:45], v6 offset:8960
  ds_read_b64 v[48:49], v6 offset:14080
  ds_read_b64 v[52:53], v6 offset:19200
  s_mov_b64 exec, s[84:85]
  ds_read_b64 v[42:43], v6 offset:3968
  ds_read_b64 v[46:47], v6 offset:9088
  ds_read_b64 v[50:51], v6 offset:14208
  ds_read_b64 v[54:55], v6 offset:19328
  s_mov_b64 exec, -1
  v_mfma_f32_16x16x32_bf16 v[116:119], v[72:75], v[56:59], v[88:91]
  v_mfma_f32_16x16x32_bf16 v[124:127], v[72:75], v[60:63], v[88:91]
  v_mfma_f32_16x16x32_bf16 v[132:135], v[72:75], v[64:67], v[88:91]
  v_mfma_f32_16x16x32_bf16 v[140:143], v[72:75], v[68:71], v[88:91]
  v_mfma_f32_16x16x32_bf16 v[112:115], v[184:187], v[56:59], 0
  v_mfma_f32_16x16x32_bf16 v[120:123], v[184:187], v[60:63], 0
  v_mfma_f32_16x16x32_bf16 v[128:131], v[184:187], v[64:67], 0
  v_mfma_f32_16x16x32_bf16 v[136:139], v[184:187], v[68:71], 0
  v_mfma_f32_16x16x32_bf16 v[160:163], v[188:191], v[56:59], v[160:163]
  v_mfma_f32_16x16x32_bf16 v[164:167], v[188:191], v[60:63], v[164:167]
  v_mfma_f32_16x16x32_bf16 v[168:171], v[188:191], v[64:67], v[168:171]
  v_mfma_f32_16x16x32_bf16 v[172:175], v[188:191], v[68:71], v[172:175]
  v_rcp_f32 v116, v116
  v_rcp_f32 v124, v124
  v_rcp_f32 v132, v132
  v_rcp_f32 v140, v140
  s_nop 0
  v_mul_f32 v116, v116, v76
  v_mul_f32 v124, v124, v77
  v_mul_f32 v132, v132, v78
  v_mul_f32 v140, v140, v79
  v_pk_mul_f32 v[112:113], v[112:113], v[116:117] op_sel_hi:[1,0]
  v_pk_mul_f32 v[114:115], v[114:115], v[116:117] op_sel_hi:[1,0]
  v_pk_mul_f32 v[120:121], v[120:121], v[124:125] op_sel_hi:[1,0]
  v_pk_mul_f32 v[122:123], v[122:123], v[124:125] op_sel_hi:[1,0]
  v_pk_mul_f32 v[128:129], v[128:129], v[132:133] op_sel_hi:[1,0]
  v_pk_mul_f32 v[130:131], v[130:131], v[132:133] op_sel_hi:[1,0]
  v_pk_mul_f32 v[136:137], v[136:137], v[140:141] op_sel_hi:[1,0]
  v_pk_mul_f32 v[138:139], v[138:139], v[140:141] op_sel_hi:[1,0]
  v_cndmask_b32 v84, v84, v116, s[76:77]
  v_cndmask_b32 v85, v85, v124, s[76:77]
  v_cndmask_b32 v86, v86, v132, s[76:77]
  v_cndmask_b32 v87, v87, v140, s[76:77]
  v_cvt_pk_bf16_f32 v98, v112, v113
  v_cvt_pk_bf16_f32 v99, v114, v115
  v_cvt_pk_bf16_f32 v102, v120, v121
  v_cvt_pk_bf16_f32 v103, v122, v123
  v_cvt_pk_bf16_f32 v106, v128, v129
  v_cvt_pk_bf16_f32 v107, v130, v131
  v_cvt_pk_bf16_f32 v110, v136, v137
  v_cvt_pk_bf16_f32 v111, v138, v139
  s_waitcnt lgkmcnt(0)
  ds_write_b128 v7, v[96:99] offset:2048
  ds_write_b128 v7, v[100:103] offset:7168
  ds_write_b128 v7, v[104:107] offset:12288
  ds_write_b128 v7, v[108:111] offset:17408
  v_mov_b32_dpp v72, v196 row_newbcast:12 row_mask:0xf bank_mask:0xf
  v_mov_b32_dpp v73, v197 row_newbcast:12 row_mask:0xf bank_mask:0xf
  v_mov_b32_dpp v74, v198 row_newbcast:12 row_mask:0xf bank_mask:0xf
  v_mov_b32_dpp v75, v199 row_newbcast:12 row_mask:0xf bank_mask:0xf
  s_nop 0
  v_cndmask_b32 v196, v196, 0, s[70:71]
  v_cndmask_b32 v197, v197, 0, s[70:71]
  v_cndmask_b32 v198, v198, 0, s[70:71]
  v_cndmask_b32 v199, v199, 0, s[70:71]
  s_waitcnt lgkmcnt(0)
  s_mov_b64 exec, s[82:83]
  ds_read_b64 v[56:57], v6 offset:4480
  ds_read_b64 v[60:61], v6 offset:9600
  ds_read_b64 v[64:65], v6 offset:14720
  ds_read_b64 v[68:69], v6 offset:19840
  s_mov_b64 exec, s[84:85]
  ds_read_b64 v[58:59], v6 offset:4608
  ds_read_b64 v[62:63], v6 offset:9728
  ds_read_b64 v[66:67], v6 offset:14848
  ds_read_b64 v[70:71], v6 offset:19968
  s_mov_b64 exec, -1
  v_mfma_f32_16x16x32_bf16 v[116:119], v[72:75], v[40:43], v[88:91]
  v_mfma_f32_16x16x32_bf16 v[124:127], v[72:75], v[44:47], v[88:91]
  v_mfma_f32_16x16x32_bf16 v[132:135], v[72:75], v[48:51], v[88:91]
  v_mfma_f32_16x16x32_bf16 v[140:143], v[72:75], v[52:55], v[88:91]
  v_mfma_f32_16x16x32_bf16 v[112:115], v[192:195], v[40:43], 0
  v_mfma_f32_16x16x32_bf16 v[120:123], v[192:195], v[44:47], 0
  v_mfma_f32_16x16x32_bf16 v[128:131], v[192:195], v[48:51], 0
  v_mfma_f32_16x16x32_bf16 v[136:139], v[192:195], v[52:55], 0
  v_mfma_f32_16x16x32_bf16 v[160:163], v[196:199], v[40:43], v[160:163]
  v_mfma_f32_16x16x32_bf16 v[164:167], v[196:199], v[44:47], v[164:167]
  v_mfma_f32_16x16x32_bf16 v[168:171], v[196:199], v[48:51], v[168:171]
  v_mfma_f32_16x16x32_bf16 v[172:175], v[196:199], v[52:55], v[172:175]
  v_rcp_f32 v116, v116
  v_rcp_f32 v124, v124
  v_rcp_f32 v132, v132
  v_rcp_f32 v140, v140
  s_nop 0
  v_mul_f32 v116, v116, v76
  v_mul_f32 v124, v124, v77
  v_mul_f32 v132, v132, v78
  v_mul_f32 v140, v140, v79
  v_pk_mul_f32 v[112:113], v[112:113], v[116:117] op_sel_hi:[1,0]
  v_pk_mul_f32 v[114:115], v[114:115], v[116:117] op_sel_hi:[1,0]
  v_pk_mul_f32 v[120:121], v[120:121], v[124:125] op_sel_hi:[1,0]
  v_pk_mul_f32 v[122:123], v[122:123], v[124:125] op_sel_hi:[1,0]
  v_pk_mul_f32 v[128:129], v[128:129], v[132:133] op_sel_hi:[1,0]
  v_pk_mul_f32 v[130:131], v[130:131], v[132:133] op_sel_hi:[1,0]
  v_pk_mul_f32 v[136:137], v[136:137], v[140:141] op_sel_hi:[1,0]
  v_pk_mul_f32 v[138:139], v[138:139], v[140:141] op_sel_hi:[1,0]
  v_cndmask_b32 v84, v84, v116, s[78:79]
  v_cndmask_b32 v85, v85, v124, s[78:79]
  v_cndmask_b32 v86, v86, v132, s[78:79]
  v_cndmask_b32 v87, v87, v140, s[78:79]
  v_cvt_pk_bf16_f32 v96, v112, v113
  v_cvt_pk_bf16_f32 v97, v114, v115
  v_cvt_pk_bf16_f32 v100, v120, v121
  v_cvt_pk_bf16_f32 v101, v122, v123
  v_cvt_pk_bf16_f32 v104, v128, v129
  v_cvt_pk_bf16_f32 v105, v130, v131
  v_cvt_pk_bf16_f32 v108, v136, v137
  v_cvt_pk_bf16_f32 v109, v138, v139
  v_mov_b32_dpp v72, v204 row_newbcast:0 row_mask:0xf bank_mask:0xf
  v_mov_b32_dpp v73, v205 row_newbcast:0 row_mask:0xf bank_mask:0xf
  v_mov_b32_dpp v74, v206 row_newbcast:0 row_mask:0xf bank_mask:0xf
  v_mov_b32_dpp v75, v207 row_newbcast:0 row_mask:0xf bank_mask:0xf
  s_nop 0
  v_cndmask_b32 v204, v204, 0, s[72:73]
  v_cndmask_b32 v205, v205, 0, s[72:73]
  v_cndmask_b32 v206, v206, 0, s[72:73]
  v_cndmask_b32 v207, v207, 0, s[72:73]
  s_waitcnt lgkmcnt(0)
  s_nop 0
  v_mfma_f32_16x16x32_bf16 v[116:119], v[72:75], v[56:59], v[88:91]
  v_mfma_f32_16x16x32_bf16 v[124:127], v[72:75], v[60:63], v[88:91]
  v_mfma_f32_16x16x32_bf16 v[132:135], v[72:75], v[64:67], v[88:91]
  v_mfma_f32_16x16x32_bf16 v[140:143], v[72:75], v[68:71], v[88:91]
  v_mfma_f32_16x16x32_bf16 v[112:115], v[200:203], v[56:59], 0
  v_mfma_f32_16x16x32_bf16 v[120:123], v[200:203], v[60:63], 0
  v_mfma_f32_16x16x32_bf16 v[128:131], v[200:203], v[64:67], 0
  v_mfma_f32_16x16x32_bf16 v[136:139], v[200:203], v[68:71], 0
  v_mfma_f32_16x16x32_bf16 v[160:163], v[204:207], v[56:59], v[160:163]
  v_mfma_f32_16x16x32_bf16 v[164:167], v[204:207], v[60:63], v[164:167]
  v_mfma_f32_16x16x32_bf16 v[168:171], v[204:207], v[64:67], v[168:171]
  v_mfma_f32_16x16x32_bf16 v[172:175], v[204:207], v[68:71], v[172:175]
  v_rcp_f32 v116, v116
  v_rcp_f32 v124, v124
  v_rcp_f32 v132, v132
  v_rcp_f32 v140, v140
  s_nop 0
  v_mul_f32 v116, v116, v76
  v_mul_f32 v124, v124, v77
  v_mul_f32 v132, v132, v78
  v_mul_f32 v140, v140, v79
  v_pk_mul_f32 v[112:113], v[112:113], v[116:117] op_sel_hi:[1,0]
  v_pk_mul_f32 v[114:115], v[114:115], v[116:117] op_sel_hi:[1,0]
  v_pk_mul_f32 v[120:121], v[120:121], v[124:125] op_sel_hi:[1,0]
  v_pk_mul_f32 v[122:123], v[122:123], v[124:125] op_sel_hi:[1,0]
  v_pk_mul_f32 v[128:129], v[128:129], v[132:133] op_sel_hi:[1,0]
  v_pk_mul_f32 v[130:131], v[130:131], v[132:133] op_sel_hi:[1,0]
  v_pk_mul_f32 v[136:137], v[136:137], v[140:141] op_sel_hi:[1,0]
  v_pk_mul_f32 v[138:139], v[138:139], v[140:141] op_sel_hi:[1,0]
  v_cndmask_b32 v84, v84, v116, s[80:81]
  v_cndmask_b32 v85, v85, v124, s[80:81]
  v_cndmask_b32 v86, v86, v132, s[80:81]
  v_cndmask_b32 v87, v87, v140, s[80:81]
  v_cvt_pk_bf16_f32 v98, v112, v113
  v_cvt_pk_bf16_f32 v99, v114, v115
  v_cvt_pk_bf16_f32 v102, v120, v121
  v_cvt_pk_bf16_f32 v103, v122, v123
  v_cvt_pk_bf16_f32 v106, v128, v129
  v_cvt_pk_bf16_f32 v107, v130, v131
  v_cvt_pk_bf16_f32 v110, v136, v137
  v_cvt_pk_bf16_f32 v111, v138, v139
  s_waitcnt lgkmcnt(0)
  ds_write_b128 v7, v[96:99] offset:3072
  ds_write_b128 v7, v[100:103] offset:8192
  ds_write_b128 v7, v[104:107] offset:13312
  ds_write_b128 v7, v[108:111] offset:18432
  v_mul_f32 v144, v144, v80
  v_mul_f32 v145, v145, v80
  v_mul_f32 v146, v146, v80
  v_mul_f32 v147, v147, v80
  v_cvt_pk_bf16_f32 v112, v144, v145
  v_cvt_pk_bf16_f32 v113, v146, v147
  v_mul_f32 v160, v160, v84
  v_mul_f32 v161, v161, v84
  v_mul_f32 v162, v162, v84
  v_mul_f32 v163, v163, v84
  v_cvt_pk_bf16_f32 v114, v160, v161
  v_cvt_pk_bf16_f32 v115, v162, v163
  ds_write_b128 v7, v[112:115] offset:4096
  v_mul_f32 v148, v148, v81
  v_mul_f32 v149, v149, v81
  v_mul_f32 v150, v150, v81
  v_mul_f32 v151, v151, v81
  v_cvt_pk_bf16_f32 v116, v148, v149
  v_cvt_pk_bf16_f32 v117, v150, v151
  v_mul_f32 v164, v164, v85
  v_mul_f32 v165, v165, v85
  v_mul_f32 v166, v166, v85
  v_mul_f32 v167, v167, v85
  v_cvt_pk_bf16_f32 v118, v164, v165
  v_cvt_pk_bf16_f32 v119, v166, v167
  ds_write_b128 v7, v[116:119] offset:9216
  v_mul_f32 v152, v152, v82
  v_mul_f32 v153, v153, v82
  v_mul_f32 v154, v154, v82
  v_mul_f32 v155, v155, v82
  v_cvt_pk_bf16_f32 v120, v152, v153
  v_cvt_pk_bf16_f32 v121, v154, v155
  v_mul_f32 v168, v168, v86
  v_mul_f32 v169, v169, v86
  v_mul_f32 v170, v170, v86
  v_mul_f32 v171, v171, v86
  v_cvt_pk_bf16_f32 v122, v168, v169
  v_cvt_pk_bf16_f32 v123, v170, v171
  ds_write_b128 v7, v[120:123] offset:14336
  v_mul_f32 v156, v156, v83
  v_mul_f32 v157, v157, v83
  v_mul_f32 v158, v158, v83
  v_mul_f32 v159, v159, v83
  v_cvt_pk_bf16_f32 v124, v156, v157
  v_cvt_pk_bf16_f32 v125, v158, v159
  v_mul_f32 v172, v172, v87
  v_mul_f32 v173, v173, v87
  v_mul_f32 v174, v174, v87
  v_mul_f32 v175, v175, v87
  v_cvt_pk_bf16_f32 v126, v172, v173
  v_cvt_pk_bf16_f32 v127, v174, v175
  ds_write_b128 v7, v[124:127] offset:19456
  s_waitcnt lgkmcnt(0)
  s_barrier
L_s2_end:
  s_endpgm
L_code_end:
.section .rodata,"a"
.p2align 6
.amdhsa_kernel s1_kernel
  .amdhsa_next_free_vgpr 256
  .amdhsa_next_free_sgpr 102
  .amdhsa_accum_offset 256
  .amdhsa_group_segment_fixed_size 0
  .amdhsa_kernarg_size 96
  .amdhsa_user_sgpr_count 2
  .amdhsa_user_sgpr_kernarg_segment_ptr 1
  .amdhsa_system_sgpr_workgroup_id_x 1
.end_amdhsa_kernel
.p2align 6
.amdhsa_kernel s2_kernel
  .amdhsa_next_free_vgpr 256
  .amdhsa_next_free_sgpr 102
  .amdhsa_accum_offset 256
  .amdhsa_group_segment_fixed_size 0
  .amdhsa_kernarg_size 96
  .amdhsa_user_sgpr_count 2
  .amdhsa_user_sgpr_kernarg_segment_ptr 1
  .amdhsa_system_sgpr_workgroup_id_x 1
.end_amdhsa_kernel
```
